```python
import torch

def _softmax(x, axis=-1):
    return torch.softmax(x, dim=axis)
def _gelu(x):
    return torch.nn.functional.gelu(x, approximate="tanh")
def _silu(x):
    return torch.nn.functional.silu(x)
def _sigmoid(x):
    return torch.sigmoid(x)
def _layernorm(x, axis=-1, eps=1e-5):
    m = x.mean(dim=axis, keepdim=True)
    v = x.var(dim=axis, keepdim=True, unbiased=False)
    return (x - m) / torch.sqrt(v + eps)
def _scatter_add(tgt, idx, src, axis=0):
    return tgt.clone().index_add_(axis, idx, src)
def _segment_sum(src, seg, n):
    out = torch.zeros((n,) + src.shape[1:], dtype=src.dtype)
    return out.index_add_(0, seg, src)
def _pad(x, pw):
    flat = tuple(v for pair in reversed(pw) for v in pair)
    return torch.nn.functional.pad(x, flat)

kernel_name = 'parallel_sum__sliding_local_dilated__glu_gated_swiglu__prompt'

def setup_inputs():

    _w = (lambda a: (lambda t: t.to(torch.bfloat16) if t.is_floating_point() else t)(torch.as_tensor(a)))
    def _A_setup():
        B, S, D = 1, 2048, 640
        return {
            "x": _w((lambda *s: torch.randn(*s, dtype=torch.bfloat16) * 0.05)(B, S, D)),
            "wqkv": _w((lambda *s: torch.randn(*s, dtype=torch.bfloat16) * 0.05)(D, 3 * D)),
            "wo": _w((lambda *s: torch.randn(*s, dtype=torch.bfloat16) * 0.05)(D, D)),
        }
    _A_in = _A_setup()

    def _B_setup():
        B, S, D, F = 1, 2048, 640, 1536
        return {
            "x": _w((lambda *s: torch.randn(*s, dtype=torch.bfloat16) * 0.05)(B, S, D)),
            "w1": _w((lambda *s: torch.randn(*s, dtype=torch.bfloat16) * 0.8)(D, F) * (2.0 / D) ** 0.5),
            "w3": _w((lambda *s: torch.randn(*s, dtype=torch.bfloat16) * 0.8)(D, F) * (2.0 / D) ** 0.5),
            "w2": _w((lambda *s: torch.randn(*s, dtype=torch.bfloat16) * 0.8)(F, D) * (2.0 / F) ** 0.5),
        }
    _B_in = _B_setup()

    return {
        "A_x": _A_in["x"],
        "A_wqkv": _A_in["wqkv"],
        "A_wo": _A_in["wo"],
        "B_x": _B_in["x"],
        "B_w1": _B_in["w1"],
        "B_w3": _B_in["w3"],
        "B_w2": _B_in["w2"],
    }

def reference(A_x, A_wqkv, A_wo, B_x, B_w1, B_w3, B_w2):
    def _A_ref(x, wqkv, wo):
        B, S, D = x.shape
        H = 32; Dh = D // H
        W, dil = 8, 2
        qkv = (lambda x, *d: x.permute(*d))((x @ wqkv).reshape(B, S, 3, H, Dh), 2, 0, 3, 1, 4)
        q, k, v = qkv[0], qkv[1], qkv[2]
        scale = Dh ** -0.5
        pos = torch.arange(S)
        off = torch.arange(W) * dil
        idx = pos[:, None] - off[None, :]
        mask = idx >= 0
        idx_c = torch.where(mask, idx, 0).reshape(-1)
        kg = k[:, :, idx_c, :].reshape(B, H, S, W, Dh)
        vg = v[:, :, idx_c, :].reshape(B, H, S, W, Dh)
        logits = torch.einsum("bhsd,bhswd->bhsw", q, kg) * scale
        logits = torch.where(mask[None, None, :, :], logits, -1e9)
        attn = _softmax(logits, axis=-1)
        o = torch.einsum("bhsw,bhswd->bhsd", attn, vg)
        return (lambda x, *d: x.permute(*d))(o, 0, 2, 1, 3).reshape(B, S, D) @ wo

    def _B_ref(x, w1, w3, w2):
        gate = torch.einsum("bsd,df->bsf", x, w1)
        up = torch.einsum("bsd,df->bsf", x, w3)
        h = _silu(gate) * up
        out = torch.einsum("bsf,fd->bsd", h, w2)
        return out

    x = A_x
    xn = _layernorm(x, axis=-1)
    return x + _A_ref(xn, A_wqkv, A_wo) + _B_ref(xn, B_w1, B_w3, B_w2)
```

```asm
; @launch kernel=k1_kernel grid=(256,1,1) block=(256,1,1) lds=161424
.amdgcn_target "amdgcn-amd-amdhsa--gfx950"
.text
.globl k1_kernel
.p2align 8
.p2align 8
k1_kernel:
    s_cmp_ge_u32 s2, 256
    s_cbranch_scc1 k1_end
    s_load_dwordx4 s[4:7], s[0:1], 0
    s_load_dwordx4 s[84:87], s[0:1], 32
    s_load_dwordx2 s[12:13], s[0:1], 72
    s_load_dwordx2 s[8:9], s[0:1], 16
    s_load_dwordx4 s[88:91], s[0:1], 48
    s_memrealtime s[96:97]
    s_lshr_b32 s14, s2, 4
    s_and_b32 s15, s2, 15
    v_and_b32 v1, 15, v0
    v_bfe_u32 v2, v0, 4, 2
    v_lshrrev_b32 v3, 6, v0
    v_and_b32 v4, 63, v0
    s_nop 1
    v_readfirstlane_b32 s16, v3
    v_and_b32 v70, 1, v3
    v_lshl_add_u32 v70, v70, 2, v2
    v_lshrrev_b32 v71, 1, v1
    v_xor_b32 v71, v71, v70
    v_and_b32 v72, 1, v1
    v_lshl_add_u32 v71, v71, 1, v72
    v_cmp_gt_u32 vcc, 5, v71
    v_mov_b32 v72, 2480
    v_mov_b32 v73, 1280
    s_nop 0
    v_cndmask_b32 v72, v72, v73, vcc
    v_cmp_gt_u32 vcc, 10, v71
    v_mov_b32 v73, -160
    s_nop 1
    v_cndmask_b32 v72, v73, v72, vcc
    v_cmp_ne_u32 s[44:45], 15, v71
    v_lshl_add_u32 v72, v71, 4, v72
    s_mul_i32 s17, s15, 80
    v_add_u32 v72, s17, v72
    v_lshl_add_u32 v73, v3, 3, v2
    v_mul_u32_u24 v73, 3840, v73
    v_add_u32 v5, v72, v73
    v_add_u32 v6, 14336, v5
    v_and_b32 v70, 1, v3
    v_mul_u32_u24 v70, 192, v70
    v_add_u32 v70, v70, v4
    s_mul_i32 s17, s15, 192
    v_add_u32 v71, 0, v70
    v_mul_u32_u24 v72, 0x5556, v71
    v_lshrrev_b32 v72, 18, v72
    v_mul_u32_u24 v73, 12, v72
    v_sub_u32 v73, v71, v73
    v_bfe_u32 v74, v72, 3, 1
    v_lshlrev_b32 v74, 1, v74
    v_xor_b32 v73, v73, v74
    v_mul_u32_u24 v72, 3072, v72
    v_lshl_add_u32 v72, v73, 4, v72
    v_add_u32 v7, s17, v72
    v_add_u32 v71, 64, v70
    v_mul_u32_u24 v72, 0x5556, v71
    v_lshrrev_b32 v72, 18, v72
    v_mul_u32_u24 v73, 12, v72
    v_sub_u32 v73, v71, v73
    v_bfe_u32 v74, v72, 3, 1
    v_lshlrev_b32 v74, 1, v74
    v_xor_b32 v73, v73, v74
    v_mul_u32_u24 v72, 3072, v72
    v_lshl_add_u32 v72, v73, 4, v72
    v_add_u32 v8, s17, v72
    v_subrev_u32 v8, 1024, v8
    v_add_u32 v71, 128, v70
    v_mul_u32_u24 v72, 0x5556, v71
    v_lshrrev_b32 v72, 18, v72
    v_mul_u32_u24 v73, 12, v72
    v_sub_u32 v73, v71, v73
    v_bfe_u32 v74, v72, 3, 1
    v_lshlrev_b32 v74, 1, v74
    v_xor_b32 v73, v73, v74
    v_mul_u32_u24 v72, 3072, v72
    v_lshl_add_u32 v72, v73, 4, v72
    v_add_u32 v9, s17, v72
    v_subrev_u32 v9, 2048, v9
    v_lshrrev_b32 v70, 3, v4
    v_and_b32 v71, 7, v4
    v_xor_b32 v71, v71, v2
    v_xor_b32 v72, 4, v71
    s_lshl_b32 s17, s14, 7
    v_lshl_add_u32 v73, v3, 5, v70
    v_add_u32 v73, s17, v73
    v_mul_u32_u24 v73, 1280, v73
    v_lshl_add_u32 v10, v71, 4, v73
    v_lshl_add_u32 v11, v72, 4, v73
    v_add_u32 v11, 9216, v11
    v_add_u32 v12, 18432, v10
    v_add_u32 v13, 18432, v11
    v_and_b32 v74, 1, v3
    v_lshl_add_u32 v73, v74, 3, v70
    s_sub_u32 s17, s17, 16
    v_add_u32 v73, s17, v73
    v_mul_i32_i24 v73, 1280, v73
    v_lshlrev_b32 v74, 2, v74
    v_xor_b32 v74, v74, v71
    v_lshl_add_u32 v14, v74, 4, v73
    s_and_b32 s17, s16, 1
    s_cmp_eq_u32 s17, 0
    s_cselect_b32 s46, 0xffffff00, -1
    s_mov_b32 s47, -1
    s_lshl_b32 s51, s16, 11
    s_mul_i32 s52, s16, 3072
    s_add_u32 s52, s52, 32768
    s_lshl_b32 s53, s16, 12
    s_add_u32 s53, s53, 81920
    s_lshl_b32 s50, s17, 10
    s_add_u32 s50, s50, 98304
    s_waitcnt lgkmcnt(0)
    s_mov_b32 s20, s4
    s_mov_b32 s21, s5
    s_mov_b32 s22, 2621440
    s_mov_b32 s23, 0x00020000
    s_mov_b32 s24, s6
    s_mov_b32 s25, s7
    s_mov_b32 s26, 2457600
    s_mov_b32 s27, 0x00020000
    s_cmp_lt_u32 s16, 2
    s_cselect_b32 s28, s84, s86
    s_cselect_b32 s29, s85, s87
    s_mov_b32 s30, 1966080
    s_mov_b32 s31, 0x00020000
    s_mov_b32 s11, s14
    s_sub_u32 s10, s11, 10
    s_cmp_lt_u32 s11, 10
    s_cselect_b32 s11, s11, s10
    s_sub_u32 s10, s11, 10
    s_cmp_lt_u32 s11, 10
    s_cselect_b32 s11, s11, s10
    s_lshl_b32 s10, s11, 1
    s_lshl_b32 s11, s11, 7
    s_add_u32 m0, s53, 0
    s_mov_b32 s72, s11
    s_add_u32 s11, s11, 128
    s_cmp_eq_u32 s11, 1280
    s_cselect_b32 s11, 0, s11
    buffer_load_dwordx4 v10, s[20:23], s72 offen offset:0 lds
    buffer_load_dwordx4 v11, s[20:23], s72 offen offset:1024 lds
    buffer_load_dwordx4 v12, s[20:23], s72 offen offset:2048 lds
    buffer_load_dwordx4 v13, s[20:23], s72 offen offset:3072 lds
    s_add_u32 m0, s50, 0
    s_mov_b64 exec, s[46:47]
    buffer_load_dwordx4 v14, s[20:23], s72 offen lds
    s_mov_b64 exec, -1
    s_add_u32 m0, s52, 0
    s_mul_i32 s49, s10, 98304
    s_mul_i32 s48, s10, 122880
    s_add_u32 s10, s10, 1
    s_cmp_eq_u32 s10, 20
    s_cselect_b32 s10, 0, s10
    buffer_load_dwordx4 v7, s[28:31], s49 offen offset:0 lds
    buffer_load_dwordx4 v8, s[28:31], s49 offen offset:1024 lds
    buffer_load_dwordx4 v9, s[28:31], s49 offen offset:2048 lds
    s_add_u32 m0, s51, 0
    s_mov_b64 exec, s[44:45]
    buffer_load_dwordx4 v5, s[24:27], s48 offen offset:0 lds
    buffer_load_dwordx4 v6, s[24:27], s48 offen offset:1024 lds
    s_mov_b64 exec, -1
    s_add_u32 m0, s52, 12288
    s_mul_i32 s49, s10, 98304
    s_mul_i32 s48, s10, 122880
    s_add_u32 s10, s10, 1
    s_cmp_eq_u32 s10, 20
    s_cselect_b32 s10, 0, s10
    buffer_load_dwordx4 v7, s[28:31], s49 offen offset:0 lds
    buffer_load_dwordx4 v8, s[28:31], s49 offen offset:1024 lds
    buffer_load_dwordx4 v9, s[28:31], s49 offen offset:2048 lds
    s_add_u32 m0, s51, 8192
    s_mov_b64 exec, s[44:45]
    buffer_load_dwordx4 v5, s[24:27], s48 offen offset:0 lds
    buffer_load_dwordx4 v6, s[24:27], s48 offen offset:1024 lds
    s_mov_b64 exec, -1
    s_add_u32 s64, s12, 32505856
    s_addc_u32 s65, s13, 0
    s_mov_b32 s66, 16384
    s_mov_b32 s67, 0x00020000
    s_or_b32 s96, s96, 1
    s_cmp_eq_u32 s2, 255
    s_cselect_b32 s98, 1, 0
    s_cselect_b32 s92, -1, 1
    s_cselect_b32 s93, -1, 0
    s_cselect_b32 s94, 1024, 0
    s_cselect_b32 s95, 2048, 0
    v_mov_b32 v58, 0
    v_mov_b32 v59, 0
    v_mov_b32 v60, 0
    v_mov_b32 v61, 0
    s_lshl_b32 s17, s2, 4
    s_add_u32 s17, s17, 8192
    s_mul_i32 s18, s16, 3072
    v_lshlrev_b32 v70, 4, v4
    v_add_u32 v71, s18, v70
    v_mov_b32 v72, s17
    s_cmp_eq_u32 s2, 255
    s_cselect_b64 vcc, -1, 0
    s_nop 1
    v_cndmask_b32 v73, v72, v71, vcc
    s_mov_b64 exec, s[92:93]
    buffer_store_dwordx4 v[58:61], v73, s[64:67], 0 offen sc1
    buffer_store_dwordx4 v[58:61], v73, s[64:67], s94 offen sc1
    buffer_store_dwordx4 v[58:61], v73, s[64:67], s95 offen sc1
    s_mov_b64 exec, -1
    v_lshl_add_u32 v71, v3, 10, v70
    v_add_u32 v71, 8192, v71
    v_add_u32 v73, 4096, v72
    v_cndmask_b32 v52, v73, v71, vcc
    v_add_u32 v71, 4096, v71
    v_cndmask_b32 v53, v72, v71, vcc
    v_and_b32 v70, 31, v0
    v_lshrrev_b32 v71, 5, v0
    v_and_b32 v72, 3, v70
    v_bfe_u32 v73, v70, 3, 1
    v_lshl_add_u32 v72, v73, 2, v72
    v_xor_b32 v72, 7, v72
    v_lshlrev_b32 v73, 8, v70
    v_lshl_add_u32 v73, v72, 5, v73
    v_lshl_add_u32 v73, v71, 13, v73
    v_add_u32 v73, 16, v73
    v_subrev_u32 v70, 128, v0
    v_lshrrev_b32 v71, 3, v70
    v_and_b32 v70, 7, v70
    v_mul_u32_u24 v71, 18432, v71
    v_lshl_add_u32 v71, v70, 4, v71
    v_add_u32 v71, 98304, v71
    v_cmp_gt_u32 vcc, 128, v0
    s_nop 1
    v_cndmask_b32 v73, v71, v73, vcc
    v_mov_b32 v74, 0x3f803f80
    v_mov_b32 v75, 0x3f803f80
    v_mov_b32 v76, 0x3f803f80
    v_mov_b32 v77, 0x3f803f80
    v_cmp_gt_u32 vcc, 152, v0
    s_nop 1
    s_mov_b64 exec, vcc
    ds_write_b128 v73, v[74:77]
    s_mov_b64 exec, -1
    s_cmp_lg_u32 s16, 0
    s_cbranch_scc1 k1_nn
    v_mov_b32 v70, 161408
    v_mov_b32 v71, s96
    ds_write_b32 v70, v71
k1_nn:
    v_and_b32 v78, 1, v3
    v_lshrrev_b32 v79, 1, v3
    v_lshrrev_b32 v70, 2, v1
    v_lshl_add_u32 v71, v2, 3, v70
    v_and_b32 v72, 1, v2
    v_lshl_add_u32 v73, v72, 2, v70
    v_and_b32 v74, 3, v1
    v_lshlrev_b32 v74, 3, v74
    v_lshl_add_u32 v75, v71, 8, v74
    v_lshl_add_u32 v76, v79, 2, 0
    v_xor_b32 v76, v76, v73
    v_lshl_add_u32 v15, v76, 5, v75
    v_lshl_add_u32 v76, v79, 2, 1
    v_xor_b32 v76, v76, v73
    v_lshl_add_u32 v16, v76, 5, v75
    v_lshl_add_u32 v76, v79, 2, 2
    v_xor_b32 v76, v76, v73
    v_lshl_add_u32 v17, v76, 5, v75
    v_lshl_add_u32 v76, v79, 2, 3
    v_xor_b32 v76, v76, v73
    v_lshl_add_u32 v18, v76, 5, v75
    v_lshl_add_u32 v76, v3, 1, 0
    v_xor_b32 v76, v76, v73
    v_lshl_add_u32 v22, v76, 5, v75
    v_lshl_add_u32 v76, v3, 1, 1
    v_xor_b32 v76, v76, v73
    v_lshl_add_u32 v23, v76, 5, v75
    v_mul_u32_u24 v75, 192, v71
    v_add_u32 v75, v75, v74
    v_add_u32 v75, 32768, v75
    v_mul_u32_u24 v77, 6144, v79
    v_mul_u32_u24 v76, 3, v79
    v_add_u32 v76, 0, v76
    v_xor_b32 v76, v76, v72
    v_lshl_add_u32 v19, v76, 5, v75
    v_mul_u32_u24 v76, 3, v78
    v_add_u32 v76, 0, v76
    v_xor_b32 v76, v76, v72
    v_lshl_add_u32 v76, v76, 5, v75
    v_add_u32 v24, v76, v77
    v_mul_u32_u24 v76, 3, v79
    v_add_u32 v76, 1, v76
    v_xor_b32 v76, v76, v72
    v_lshl_add_u32 v20, v76, 5, v75
    v_mul_u32_u24 v76, 3, v78
    v_add_u32 v76, 1, v76
    v_xor_b32 v76, v76, v72
    v_lshl_add_u32 v76, v76, 5, v75
    v_add_u32 v25, v76, v77
    v_mul_u32_u24 v76, 3, v79
    v_add_u32 v76, 2, v76
    v_xor_b32 v76, v76, v72
    v_lshl_add_u32 v21, v76, 5, v75
    v_mul_u32_u24 v76, 3, v78
    v_add_u32 v76, 2, v76
    v_xor_b32 v76, v76, v72
    v_lshl_add_u32 v76, v76, 5, v75
    v_add_u32 v26, v76, v77
    v_lshrrev_b32 v70, 1, v1
    v_xor_b32 v70, v70, v2
    v_lshlrev_b32 v71, 7, v1
    v_lshl_add_u32 v71, v70, 4, v71
    v_add_u32 v252, 98304, v71
    v_xor_b32 v253, 64, v252
    v_lshl_add_u32 v71, v78, 13, v71
    v_add_u32 v71, 81920, v71
    v_lshl_add_u32 v248, v79, 12, v71
    v_xor_b32 v249, 64, v248
    v_xor_b32 v250, 0x1000, v248
    v_xor_b32 v251, 64, v250
    s_add_u32 m0, s53, 18432
    s_mov_b32 s72, s11
    s_add_u32 s11, s11, 128
    s_cmp_eq_u32 s11, 1280
    s_cselect_b32 s11, 0, s11
    buffer_load_dwordx4 v10, s[20:23], s72 offen offset:0 lds
    buffer_load_dwordx4 v11, s[20:23], s72 offen offset:1024 lds
    buffer_load_dwordx4 v12, s[20:23], s72 offen offset:2048 lds
    buffer_load_dwordx4 v13, s[20:23], s72 offen offset:3072 lds
    s_add_u32 m0, s50, 18432
    s_mov_b64 exec, s[46:47]
    buffer_load_dwordx4 v14, s[20:23], s72 offen lds
    s_mov_b64 exec, -1
    s_add_u32 m0, s52, 24576
    s_mul_i32 s49, s10, 98304
    s_mul_i32 s48, s10, 122880
    s_add_u32 s10, s10, 1
    s_cmp_eq_u32 s10, 20
    s_cselect_b32 s10, 0, s10
    buffer_load_dwordx4 v7, s[28:31], s49 offen offset:0 lds
    buffer_load_dwordx4 v8, s[28:31], s49 offen offset:1024 lds
    buffer_load_dwordx4 v9, s[28:31], s49 offen offset:2048 lds
    s_add_u32 m0, s51, 16384
    s_mov_b64 exec, s[44:45]
    buffer_load_dwordx4 v5, s[24:27], s48 offen offset:0 lds
    buffer_load_dwordx4 v6, s[24:27], s48 offen offset:1024 lds
    s_mov_b64 exec, -1
    s_add_u32 m0, s53, 36864
    s_mov_b32 s72, s11
    s_add_u32 s11, s11, 128
    s_cmp_eq_u32 s11, 1280
    s_cselect_b32 s11, 0, s11
    buffer_load_dwordx4 v10, s[20:23], s72 offen offset:0 lds
    buffer_load_dwordx4 v11, s[20:23], s72 offen offset:1024 lds
    buffer_load_dwordx4 v12, s[20:23], s72 offen offset:2048 lds
    buffer_load_dwordx4 v13, s[20:23], s72 offen offset:3072 lds
    s_add_u32 m0, s50, 36864
    s_mov_b64 exec, s[46:47]
    buffer_load_dwordx4 v14, s[20:23], s72 offen lds
    s_mov_b64 exec, -1
    s_mov_b32 s36, s12
    s_mov_b32 s37, s13
    s_mov_b32 s38, 2621440
    s_mov_b32 s39, 0x00020000
    s_add_u32 s40, s12, 4194304
    s_addc_u32 s41, s13, 0
    s_mov_b32 s42, 6291456
    s_mov_b32 s43, 0x00020000
    s_add_u32 s68, s12, 29360128
    s_addc_u32 s69, s13, 0
    s_mov_b32 s70, 2785280
    s_mov_b32 s71, 0x00020000
    s_mov_b32 s76, s90
    s_mov_b32 s77, s91
    s_mov_b32 s78, 2621440
    s_mov_b32 s79, 0x00020000
    s_and_b32 s80, s2, 7
    s_lshl_b32 s80, s80, 2
    s_bfe_u32 s81, s2, 0x20003
    s_add_u32 s80, s80, s81
    s_lshr_b32 s81, s2, 5
    s_mul_i32 s82, s81, 348160
    v_lshlrev_b32 v30, 4, v4
    v_mul_u32_u24 v47, 5120, v3
    v_add_u32 v47, v47, v30
    v_add_u32 v47, s82, v47
    v_lshlrev_b32 v80, 1, v79
    v_lshl_add_u32 v80, v78, 2, v80
    v_xor_b32 v81, 2, v80
    v_lshl_add_u32 v70, v80, 4, v1
    v_add_u32 v70, 16, v70
    v_mul_u32_u24 v70, 528, v70
    v_lshl_add_u32 v70, v2, 4, v70
    v_lshl_add_u32 v70, v79, 8, v70
    v_add_u32 v31, 81920, v70
    v_lshl_add_u32 v70, v81, 4, v1
    v_add_u32 v70, 16, v70
    v_mul_u32_u24 v70, 528, v70
    v_lshl_add_u32 v70, v2, 4, v70
    v_lshl_add_u32 v70, v79, 8, v70
    v_add_u32 v32, 81920, v70
    v_mul_u32_u24 v70, 528, v1
    v_lshl_add_u32 v70, v2, 4, v70
    v_add_u32 v70, 81920, v70
    v_lshl_add_u32 v33, v3, 7, v70
    s_lshl_b32 s17, s14, 3
    s_mul_i32 s17, s17, 49152
    s_mul_i32 s18, s15, 3072
    s_add_u32 s17, s17, s18
    v_lshrrev_b32 v70, 1, v2
    v_lshlrev_b32 v70, 8, v70
    v_lshl_add_u32 v70, v1, 4, v70
    v_and_b32 v71, 1, v2
    v_lshl_add_u32 v70, v71, 3, v70
    v_add_u32 v70, s17, v70
    v_mul_u32_u24 v71, 1536, v79
    v_add_u32 v70, v70, v71
    v_mul_u32_u24 v71, 49152, v80
    v_add_u32 v35, v70, v71
    v_add_u32 v36, 49152, v35
    v_mul_u32_u24 v71, 49152, v81
    v_add_u32 v37, v70, v71
    v_add_u32 v38, 49152, v37
    s_mov_b32 s54, 0xbfb8aa3b
    s_mov_b32 s55, 0xbfb8aa3b
    s_mov_b32 s56, 1.0
    s_mov_b32 s57, 1.0
    s_mov_b32 s58, 0xffff0000
    v_and_b32 v70, 127, v0
    v_lshrrev_b32 v71, 7, v0
    v_add_u32 v39, 16, v70
    v_mul_u32_u24 v39, 528, v39
    v_mul_u32_u24 v72, 80, v71
    v_add_u32 v39, v39, v72
    v_add_u32 v39, 81920, v39
    v_add_u32 v40, -7392, v39
    s_lshl_b32 s17, s14, 7
    v_add_u32 v41, s17, v70
    v_lshrrev_b32 v73, 4, v41
    v_mul_u32_u24 v73, 20480, v73
    v_and_b32 v72, 15, v41
    v_lshl_add_u32 v73, v72, 4, v73
    v_mul_u32_u24 v72, 20, v71
    s_mul_i32 s18, s15, 40
    v_add_u32 v72, s18, v72
    v_add_u32 v74, 0, v72
    v_lshrrev_b32 v70, 5, v74
    v_lshl_add_u32 v42, v70, 10, v73
    v_bfe_u32 v70, v74, 3, 2
    v_lshl_add_u32 v42, v70, 8, v42
    v_bfe_u32 v70, v74, 2, 1
    v_lshl_add_u32 v42, v70, 3, v42
    v_add_u32 v74, 4, v72
    v_lshrrev_b32 v70, 5, v74
    v_lshl_add_u32 v43, v70, 10, v73
    v_bfe_u32 v70, v74, 3, 2
    v_lshl_add_u32 v43, v70, 8, v43
    v_bfe_u32 v70, v74, 2, 1
    v_lshl_add_u32 v43, v70, 3, v43
    v_add_u32 v74, 8, v72
    v_lshrrev_b32 v70, 5, v74
    v_lshl_add_u32 v44, v70, 10, v73
    v_bfe_u32 v70, v74, 3, 2
    v_lshl_add_u32 v44, v70, 8, v44
    v_bfe_u32 v70, v74, 2, 1
    v_lshl_add_u32 v44, v70, 3, v44
    v_add_u32 v74, 12, v72
    v_lshrrev_b32 v70, 5, v74
    v_lshl_add_u32 v45, v70, 10, v73
    v_bfe_u32 v70, v74, 3, 2
    v_lshl_add_u32 v45, v70, 8, v45
    v_bfe_u32 v70, v74, 2, 1
    v_lshl_add_u32 v45, v70, 3, v45
    v_add_u32 v74, 16, v72
    v_lshrrev_b32 v70, 5, v74
    v_lshl_add_u32 v46, v70, 10, v73
    v_bfe_u32 v70, v74, 3, 2
    v_lshl_add_u32 v46, v70, 8, v46
    v_bfe_u32 v70, v74, 2, 1
    v_lshl_add_u32 v46, v70, 3, v46
    s_lshl_b32 s17, s14, 7
    v_mov_b32 v48, s17
    s_lshr_b32 s17, s80, 1
    s_lshl_b32 s17, s17, 7
    v_mov_b32 v49, s17
    v_mov_b32 v50, 1
    s_lshl_b32 s17, s81, 7
    s_add_u32 s17, s17, 4096
    v_mov_b32 v34, s17
    s_lshl_b32 s60, s16, 8
    s_add_u32 s60, s60, s2
    s_mul_hi_u32 s61, s60, 63161284
    s_mul_i32 s62, s61, 68
    s_sub_u32 s62, s60, s62
    s_sub_u32 s63, s62, 20
    s_cmp_lt_u32 s62, 20
    s_cselect_b32 s32, s8, s88
    s_cselect_b32 s33, s9, s89
    s_mov_b32 s34, 1966080
    s_cselect_b32 s34, 819200, s34
    s_mov_b32 s35, 0x00020000
    s_cselect_b32 s63, s62, s63
    s_mul_i32 s83, s63, 40960
    s_lshl_b32 s62, s61, 7
    s_add_u32 s62, s62, 4096
    s_mul_i32 s61, s61, 160
    s_add_u32 s83, s83, s61
    s_cmp_lt_u32 s60, 544
    s_cselect_b32 s83, s83, 0x7f000000
    s_cselect_b32 s62, s62, 0x7f000000
    v_mov_b32 v27, s62
    s_mul_i32 s59, s16, 5120
    s_add_u32 s59, s59, 137216
    v_add_u32 v70, 0, v4
    v_mul_u32_u24 v71, 0x199a, v70
    v_lshrrev_b32 v71, 16, v71
    v_mul_u32_u24 v72, 10, v71
    v_sub_u32 v72, v70, v72
    v_mul_u32_u24 v71, 1280, v71
    v_lshl_add_u32 v62, v72, 4, v71
    v_add_u32 v70, 64, v4
    v_mul_u32_u24 v71, 0x199a, v70
    v_lshrrev_b32 v71, 16, v71
    v_mul_u32_u24 v72, 10, v71
    v_sub_u32 v72, v70, v72
    v_mul_u32_u24 v71, 1280, v71
    v_lshl_add_u32 v63, v72, 4, v71
    v_add_u32 v70, 128, v4
    v_mul_u32_u24 v71, 0x199a, v70
    v_lshrrev_b32 v71, 16, v71
    v_mul_u32_u24 v72, 10, v71
    v_sub_u32 v72, v70, v72
    v_mul_u32_u24 v71, 1280, v71
    v_lshl_add_u32 v64, v72, 4, v71
    v_add_u32 v70, 192, v4
    v_mul_u32_u24 v71, 0x199a, v70
    v_lshrrev_b32 v71, 16, v71
    v_mul_u32_u24 v72, 10, v71
    v_sub_u32 v72, v70, v72
    v_mul_u32_u24 v71, 1280, v71
    v_lshl_add_u32 v65, v72, 4, v71
    v_add_u32 v70, 256, v4
    v_mul_u32_u24 v71, 0x199a, v70
    v_lshrrev_b32 v71, 16, v71
    v_mul_u32_u24 v72, 10, v71
    v_sub_u32 v72, v70, v72
    v_mul_u32_u24 v71, 1280, v71
    v_lshl_add_u32 v66, v72, 4, v71
    v_lshrrev_b32 v70, 2, v1
    v_lshl_add_u32 v70, v2, 3, v70
    v_mul_u32_u24 v70, 160, v70
    v_and_b32 v71, 3, v1
    v_lshl_add_u32 v70, v71, 3, v70
    v_add_u32 v67, s59, v70
    s_mul_i32 s60, s60, 5120
    v_add_u32 v29, s60, v30
    s_movk_i32 s99, 4096
    v_readfirstlane_b32 s73, v80
    v_readfirstlane_b32 s74, v81
    s_waitcnt vmcnt(23)
    s_waitcnt lgkmcnt(0)
    s_barrier
    v_mov_b32 v70, 161408
    ds_read_b32 v71, v70
    ds_read_b128 a[52:55], v248 offset:0
    ds_read_b128 a[56:59], v248 offset:2048
    ds_read_b128 a[60:63], v250 offset:0
    ds_read_b128 a[64:67], v250 offset:2048
    ds_read_b128 a[68:71], v252 offset:0
    ds_read_b64_tr_b16 a[0:1], v15 offset:0
    ds_read_b64_tr_b16 a[2:3], v15 offset:1024
    ds_read_b64_tr_b16 a[4:5], v16 offset:0
    ds_read_b64_tr_b16 a[6:7], v16 offset:1024
    ds_read_b64_tr_b16 a[8:9], v17 offset:0
    ds_read_b64_tr_b16 a[10:11], v17 offset:1024
    ds_read_b64_tr_b16 a[12:13], v18 offset:0
    ds_read_b64_tr_b16 a[14:15], v18 offset:1024
    s_waitcnt lgkmcnt(13)
    v_readfirstlane_b32 s96, v71
    s_cmp_eq_u32 s98, 0
    s_cselect_b32 s17, s96, 0
    v_mov_b32 v58, s17
    v_mov_b32 v59, s17
    v_mov_b32 v60, s17
    v_mov_b32 v61, s17
    s_mov_b64 exec, s[92:93]
    buffer_store_dwordx4 v[58:61], v53, s[64:67], 0 offen sc1
    s_mov_b64 exec, -1
    s_waitcnt vmcnt(19)
    s_barrier
    ds_read_b64_tr_b16 a[16:17], v19 offset:0
    ds_read_b64_tr_b16 a[18:19], v19 offset:768
    ds_read_b64_tr_b16 a[32:33], v22 offset:0
    ds_read_b64_tr_b16 a[34:35], v22 offset:1024
    s_waitcnt lgkmcnt(12)
    s_waitcnt lgkmcnt(10)
    v_mfma_f32_16x16x32_bf16 v[88:91], a[0:3], a[52:55], 0
    v_mfma_f32_16x16x32_bf16 v[92:95], a[0:3], a[56:59], 0
    v_mfma_f32_16x16x32_bf16 v[96:99], a[0:3], a[60:63], 0
    v_mfma_f32_16x16x32_bf16 v[100:103], a[0:3], a[64:67], 0
    v_mfma_f32_16x16x32_bf16 a[112:115], a[52:55], a[52:55], 0
    s_add_u32 m0, s52, 36864
    s_mul_i32 s49, s10, 98304
    s_mul_i32 s48, s10, 122880
    s_add_u32 s10, s10, 1
    s_cmp_eq_u32 s10, 20
    s_cselect_b32 s10, 0, s10
    buffer_load_dwordx4 v7, s[28:31], s49 offen offset:0 lds
    ds_read_b64_tr_b16 a[20:21], v20 offset:0
    ds_read_b64_tr_b16 a[22:23], v20 offset:768
    s_waitcnt lgkmcnt(10)
    v_mfma_f32_16x16x32_bf16 v[104:107], a[4:7], a[52:55], 0
    v_mfma_f32_16x16x32_bf16 v[108:111], a[4:7], a[56:59], 0
    v_mfma_f32_16x16x32_bf16 v[112:115], a[4:7], a[60:63], 0
    v_mfma_f32_16x16x32_bf16 v[116:119], a[4:7], a[64:67], 0
    s_waitcnt lgkmcnt(2)
    v_mfma_f32_16x16x32_bf16 a[92:95], a[32:35], a[68:71], 0
    buffer_load_dwordx4 v8, s[28:31], s49 offen offset:1024 lds
    ds_read_b64_tr_b16 a[24:25], v21 offset:0
    ds_read_b64_tr_b16 a[26:27], v21 offset:768
    ds_read_b64_tr_b16 a[36:37], v23 offset:0
    ds_read_b64_tr_b16 a[38:39], v23 offset:1024
    v_mfma_f32_16x16x32_bf16 v[120:123], a[8:11], a[52:55], 0
    v_mfma_f32_16x16x32_bf16 v[124:127], a[8:11], a[56:59], 0
    v_mfma_f32_16x16x32_bf16 v[128:131], a[8:11], a[60:63], 0
    v_mfma_f32_16x16x32_bf16 v[132:135], a[8:11], a[64:67], 0
    v_mfma_f32_16x16x32_bf16 a[116:119], a[56:59], a[56:59], 0
    buffer_load_dwordx4 v9, s[28:31], s49 offen offset:2048 lds
    ds_read_b64_tr_b16 a[28:29], v19 offset:6144
    ds_read_b64_tr_b16 a[30:31], v19 offset:6912
    v_mfma_f32_16x16x32_bf16 v[136:139], a[12:15], a[52:55], 0
    v_mfma_f32_16x16x32_bf16 v[140:143], a[12:15], a[56:59], 0
    v_mfma_f32_16x16x32_bf16 v[144:147], a[12:15], a[60:63], 0
    v_mfma_f32_16x16x32_bf16 v[148:151], a[12:15], a[64:67], 0
    s_waitcnt lgkmcnt(2)
    v_mfma_f32_16x16x32_bf16 a[96:99], a[36:39], a[68:71], 0
    s_add_u32 m0, s51, 24576
    s_mov_b64 exec, s[44:45]
    buffer_load_dwordx4 v5, s[24:27], s48 offen offset:0 lds
    buffer_load_dwordx4 v6, s[24:27], s48 offen offset:1024 lds
    s_mov_b64 exec, -1
    ds_read_b64_tr_b16 a[0:1], v20 offset:6144
    ds_read_b64_tr_b16 a[2:3], v20 offset:6912
    ds_read_b64_tr_b16 a[40:41], v24 offset:0
    ds_read_b64_tr_b16 a[42:43], v24 offset:768
    v_mfma_f32_16x16x32_bf16 v[152:155], a[16:19], a[52:55], 0
    v_mfma_f32_16x16x32_bf16 v[156:159], a[16:19], a[56:59], 0
    ds_read_b128 a[72:75], v249 offset:0
    v_mfma_f32_16x16x32_bf16 v[160:163], a[16:19], a[60:63], 0
    v_mfma_f32_16x16x32_bf16 v[164:167], a[16:19], a[64:67], 0
    v_mfma_f32_16x16x32_bf16 a[120:123], a[68:71], a[68:71], 0
    ds_read_b64_tr_b16 a[4:5], v21 offset:6144
    ds_read_b64_tr_b16 a[6:7], v21 offset:6912
    v_mfma_f32_16x16x32_bf16 v[168:171], a[20:23], a[52:55], 0
    v_mfma_f32_16x16x32_bf16 v[172:175], a[20:23], a[56:59], 0
    ds_read_b128 a[76:79], v249 offset:2048
    v_mfma_f32_16x16x32_bf16 v[176:179], a[20:23], a[60:63], 0
    v_mfma_f32_16x16x32_bf16 v[180:183], a[20:23], a[64:67], 0
    s_waitcnt lgkmcnt(4)
    v_mfma_f32_16x16x32_bf16 a[100:103], a[40:43], a[68:71], 0
    ds_read_b64_tr_b16 a[8:9], v15 offset:8192
    ds_read_b64_tr_b16 a[10:11], v15 offset:9216
    ds_read_b64_tr_b16 a[44:45], v25 offset:0
    ds_read_b64_tr_b16 a[46:47], v25 offset:768
    v_mfma_f32_16x16x32_bf16 v[184:187], a[24:27], a[52:55], 0
    v_mfma_f32_16x16x32_bf16 v[188:191], a[24:27], a[56:59], 0
    ds_read_b128 a[80:83], v251 offset:0
    v_mfma_f32_16x16x32_bf16 v[192:195], a[24:27], a[60:63], 0
    v_mfma_f32_16x16x32_bf16 v[196:199], a[24:27], a[64:67], 0
    ds_read_b64_tr_b16 a[12:13], v16 offset:8192
    ds_read_b64_tr_b16 a[14:15], v16 offset:9216
    v_mfma_f32_16x16x32_bf16 v[200:203], a[28:31], a[52:55], 0
    v_mfma_f32_16x16x32_bf16 v[204:207], a[28:31], a[56:59], 0
    ds_read_b128 a[84:87], v251 offset:2048
    v_mfma_f32_16x16x32_bf16 v[208:211], a[28:31], a[60:63], 0
    v_mfma_f32_16x16x32_bf16 v[212:215], a[28:31], a[64:67], 0
    s_waitcnt lgkmcnt(4)
    v_mfma_f32_16x16x32_bf16 a[104:107], a[44:47], a[68:71], 0
    ds_read_b64_tr_b16 a[16:17], v17 offset:8192
    ds_read_b64_tr_b16 a[18:19], v17 offset:9216
    ds_read_b64_tr_b16 a[48:49], v26 offset:0
    ds_read_b64_tr_b16 a[50:51], v26 offset:768
    v_mfma_f32_16x16x32_bf16 v[216:219], a[0:3], a[52:55], 0
    v_mfma_f32_16x16x32_bf16 v[220:223], a[0:3], a[56:59], 0
    ds_read_b128 a[88:91], v253 offset:0
    v_mfma_f32_16x16x32_bf16 v[224:227], a[0:3], a[60:63], 0
    v_mfma_f32_16x16x32_bf16 v[228:231], a[0:3], a[64:67], 0
    ds_read_b64_tr_b16 a[20:21], v18 offset:8192
    ds_read_b64_tr_b16 a[22:23], v18 offset:9216
    v_mfma_f32_16x16x32_bf16 v[232:235], a[4:7], a[52:55], 0
    v_mfma_f32_16x16x32_bf16 v[236:239], a[4:7], a[56:59], 0
    v_mfma_f32_16x16x32_bf16 v[240:243], a[4:7], a[60:63], 0
    v_mfma_f32_16x16x32_bf16 v[244:247], a[4:7], a[64:67], 0
    s_waitcnt lgkmcnt(3)
    v_mfma_f32_16x16x32_bf16 a[108:111], a[48:51], a[68:71], 0
    s_waitcnt vmcnt(11)
    s_barrier
    ds_read_b64_tr_b16 a[24:25], v19 offset:12288
    ds_read_b64_tr_b16 a[26:27], v19 offset:13056
    ds_read_b64_tr_b16 a[32:33], v22 offset:8192
    ds_read_b64_tr_b16 a[34:35], v22 offset:9216
    s_waitcnt lgkmcnt(6)
    v_mfma_f32_16x16x32_bf16 v[88:91], a[8:11], a[72:75], v[88:91]
    v_mfma_f32_16x16x32_bf16 v[92:95], a[8:11], a[76:79], v[92:95]
    s_add_u32 m0, s59, 0
    s_nop 0
    buffer_load_dwordx4 v62, s[32:35], s83 offen lds
    v_mfma_f32_16x16x32_bf16 v[96:99], a[8:11], a[80:83], v[96:99]
    v_mfma_f32_16x16x32_bf16 v[100:103], a[8:11], a[84:87], v[100:103]
    v_mfma_f32_16x16x32_bf16 a[112:115], a[72:75], a[72:75], a[112:115]
    s_add_u32 m0, s52, 0
    s_mul_i32 s49, s10, 98304
    s_mul_i32 s48, s10, 122880
    s_add_u32 s10, s10, 1
    s_cmp_eq_u32 s10, 20
    s_cselect_b32 s10, 0, s10
    buffer_load_dwordx4 v7, s[28:31], s49 offen offset:0 lds
    ds_read_b64_tr_b16 a[28:29], v20 offset:12288
    ds_read_b64_tr_b16 a[30:31], v20 offset:13056
    v_mfma_f32_16x16x32_bf16 v[104:107], a[12:15], a[72:75], v[104:107]
    v_mfma_f32_16x16x32_bf16 v[108:111], a[12:15], a[76:79], v[108:111]
    s_add_u32 m0, s59, 1024
    s_nop 0
    buffer_load_dwordx4 v63, s[32:35], s83 offen lds
    v_mfma_f32_16x16x32_bf16 v[112:115], a[12:15], a[80:83], v[112:115]
    v_mfma_f32_16x16x32_bf16 v[116:119], a[12:15], a[84:87], v[116:119]
    s_waitcnt lgkmcnt(2)
    v_mfma_f32_16x16x32_bf16 a[92:95], a[32:35], a[88:91], a[92:95]
    s_add_u32 m0, s52, 0
    s_nop 0
    buffer_load_dwordx4 v8, s[28:31], s49 offen offset:1024 lds
    ds_read_b64_tr_b16 a[0:1], v21 offset:12288
    ds_read_b64_tr_b16 a[2:3], v21 offset:13056
    ds_read_b64_tr_b16 a[36:37], v23 offset:8192
    ds_read_b64_tr_b16 a[38:39], v23 offset:9216
    v_mfma_f32_16x16x32_bf16 v[120:123], a[16:19], a[72:75], v[120:123]
    v_mfma_f32_16x16x32_bf16 v[124:127], a[16:19], a[76:79], v[124:127]
    s_add_u32 m0, s59, 2048
    s_nop 0
    buffer_load_dwordx4 v64, s[32:35], s83 offen lds
    v_mfma_f32_16x16x32_bf16 v[128:131], a[16:19], a[80:83], v[128:131]
    v_mfma_f32_16x16x32_bf16 v[132:135], a[16:19], a[84:87], v[132:135]
    v_mfma_f32_16x16x32_bf16 a[116:119], a[76:79], a[76:79], a[116:119]
    s_add_u32 m0, s52, 0
    s_nop 0
    buffer_load_dwordx4 v9, s[28:31], s49 offen offset:2048 lds
    ds_read_b64_tr_b16 a[4:5], v19 offset:18432
    ds_read_b64_tr_b16 a[6:7], v19 offset:19200
    v_mfma_f32_16x16x32_bf16 v[136:139], a[20:23], a[72:75], v[136:139]
    v_mfma_f32_16x16x32_bf16 v[140:143], a[20:23], a[76:79], v[140:143]
    s_add_u32 m0, s59, 3072
    s_nop 0
    buffer_load_dwordx4 v65, s[32:35], s83 offen lds
    v_mfma_f32_16x16x32_bf16 v[144:147], a[20:23], a[80:83], v[144:147]
    v_mfma_f32_16x16x32_bf16 v[148:151], a[20:23], a[84:87], v[148:151]
    s_waitcnt lgkmcnt(2)
    v_mfma_f32_16x16x32_bf16 a[96:99], a[36:39], a[88:91], a[96:99]
    s_add_u32 m0, s51, 0
    s_mov_b64 exec, s[44:45]
    buffer_load_dwordx4 v5, s[24:27], s48 offen offset:0 lds
    buffer_load_dwordx4 v6, s[24:27], s48 offen offset:1024 lds
    s_mov_b64 exec, -1
    ds_read_b64_tr_b16 a[8:9], v20 offset:18432
    ds_read_b64_tr_b16 a[10:11], v20 offset:19200
    ds_read_b64_tr_b16 a[40:41], v24 offset:12288
    ds_read_b64_tr_b16 a[42:43], v24 offset:13056
    v_mfma_f32_16x16x32_bf16 v[152:155], a[24:27], a[72:75], v[152:155]
    v_mfma_f32_16x16x32_bf16 v[156:159], a[24:27], a[76:79], v[156:159]
    s_add_u32 m0, s59, 4096
    s_nop 0
    buffer_load_dwordx4 v66, s[32:35], s83 offen lds
    ds_read_b128 a[52:55], v248 offset:18432
    v_mfma_f32_16x16x32_bf16 v[160:163], a[24:27], a[80:83], v[160:163]
    v_mfma_f32_16x16x32_bf16 v[164:167], a[24:27], a[84:87], v[164:167]
    v_mfma_f32_16x16x32_bf16 a[120:123], a[88:91], a[88:91], a[120:123]
    s_add_u32 m0, s53, 0
    s_mov_b32 s72, s11
    s_add_u32 s11, s11, 128
    s_cmp_eq_u32 s11, 1280
    s_cselect_b32 s11, 0, s11
    buffer_load_dwordx4 v10, s[20:23], s72 offen offset:0 lds
    ds_read_b64_tr_b16 a[12:13], v21 offset:18432
    ds_read_b64_tr_b16 a[14:15], v21 offset:19200
    v_mfma_f32_16x16x32_bf16 v[168:171], a[28:31], a[72:75], v[168:171]
    v_mfma_f32_16x16x32_bf16 v[172:175], a[28:31], a[76:79], v[172:175]
    ds_read_b128 a[56:59], v248 offset:20480
    v_mfma_f32_16x16x32_bf16 v[176:179], a[28:31], a[80:83], v[176:179]
    v_mfma_f32_16x16x32_bf16 v[180:183], a[28:31], a[84:87], v[180:183]
    s_waitcnt lgkmcnt(4)
    v_mfma_f32_16x16x32_bf16 a[100:103], a[40:43], a[88:91], a[100:103]
    buffer_load_dwordx4 v11, s[20:23], s72 offen offset:1024 lds
    ds_read_b64_tr_b16 a[16:17], v15 offset:16384
    ds_read_b64_tr_b16 a[18:19], v15 offset:17408
    ds_read_b64_tr_b16 a[44:45], v25 offset:12288
    ds_read_b64_tr_b16 a[46:47], v25 offset:13056
    v_mfma_f32_16x16x32_bf16 v[184:187], a[0:3], a[72:75], v[184:187]
    v_mfma_f32_16x16x32_bf16 v[188:191], a[0:3], a[76:79], v[188:191]
    ds_read_b128 a[60:63], v250 offset:18432
    v_mfma_f32_16x16x32_bf16 v[192:195], a[0:3], a[80:83], v[192:195]
    v_mfma_f32_16x16x32_bf16 v[196:199], a[0:3], a[84:87], v[196:199]
    buffer_load_dwordx4 v12, s[20:23], s72 offen offset:2048 lds
    ds_read_b64_tr_b16 a[20:21], v16 offset:16384
    ds_read_b64_tr_b16 a[22:23], v16 offset:17408
    v_mfma_f32_16x16x32_bf16 v[200:203], a[4:7], a[72:75], v[200:203]
    v_mfma_f32_16x16x32_bf16 v[204:207], a[4:7], a[76:79], v[204:207]
    ds_read_b128 a[64:67], v250 offset:20480
    v_mfma_f32_16x16x32_bf16 v[208:211], a[4:7], a[80:83], v[208:211]
    v_mfma_f32_16x16x32_bf16 v[212:215], a[4:7], a[84:87], v[212:215]
    s_waitcnt lgkmcnt(4)
    v_mfma_f32_16x16x32_bf16 a[104:107], a[44:47], a[88:91], a[104:107]
    buffer_load_dwordx4 v13, s[20:23], s72 offen offset:3072 lds
    ds_read_b64_tr_b16 a[24:25], v17 offset:16384
    ds_read_b64_tr_b16 a[26:27], v17 offset:17408
    ds_read_b64_tr_b16 a[48:49], v26 offset:12288
    ds_read_b64_tr_b16 a[50:51], v26 offset:13056
    v_mfma_f32_16x16x32_bf16 v[216:219], a[8:11], a[72:75], v[216:219]
    v_mfma_f32_16x16x32_bf16 v[220:223], a[8:11], a[76:79], v[220:223]
    ds_read_b128 a[68:71], v252 offset:18432
    v_mfma_f32_16x16x32_bf16 v[224:227], a[8:11], a[80:83], v[224:227]
    v_mfma_f32_16x16x32_bf16 v[228:231], a[8:11], a[84:87], v[228:231]
    s_add_u32 m0, s50, 0
    s_mov_b64 exec, s[46:47]
    buffer_load_dwordx4 v14, s[20:23], s72 offen lds
    s_mov_b64 exec, -1
    ds_read_b64_tr_b16 a[28:29], v18 offset:16384
    ds_read_b64_tr_b16 a[30:31], v18 offset:17408
    v_mfma_f32_16x16x32_bf16 v[232:235], a[12:15], a[72:75], v[232:235]
    v_mfma_f32_16x16x32_bf16 v[236:239], a[12:15], a[76:79], v[236:239]
    v_mfma_f32_16x16x32_bf16 v[240:243], a[12:15], a[80:83], v[240:243]
    v_mfma_f32_16x16x32_bf16 v[244:247], a[12:15], a[84:87], v[244:247]
    s_waitcnt lgkmcnt(3)
    v_mfma_f32_16x16x32_bf16 a[108:111], a[48:51], a[88:91], a[108:111]
    s_waitcnt vmcnt(15)
    s_barrier
    ds_read_b64_tr_b16 a[0:1], v19 offset:24576
    ds_read_b64_tr_b16 a[2:3], v19 offset:25344
    ds_read_b64_tr_b16 a[32:33], v22 offset:16384
    ds_read_b64_tr_b16 a[34:35], v22 offset:17408
    s_waitcnt lgkmcnt(6)
    v_mfma_f32_16x16x32_bf16 v[88:91], a[16:19], a[52:55], v[88:91]
    v_mfma_f32_16x16x32_bf16 v[92:95], a[16:19], a[56:59], v[92:95]
    s_mov_b64 exec, s[92:93]
    buffer_store_dwordx4 v[58:61], v53, s[64:67], 0 offen sc1
    s_mov_b64 exec, -1
    v_mfma_f32_16x16x32_bf16 v[96:99], a[16:19], a[60:63], v[96:99]
    v_mfma_f32_16x16x32_bf16 v[100:103], a[16:19], a[64:67], v[100:103]
    v_mfma_f32_16x16x32_bf16 a[112:115], a[52:55], a[52:55], a[112:115]
    s_add_u32 m0, s52, 12288
    s_mul_i32 s49, s10, 98304
    s_mul_i32 s48, s10, 122880
    s_add_u32 s10, s10, 1
    s_cmp_eq_u32 s10, 20
    s_cselect_b32 s10, 0, s10
    buffer_load_dwordx4 v7, s[28:31], s49 offen offset:0 lds
    ds_read_b64_tr_b16 a[4:5], v20 offset:24576
    ds_read_b64_tr_b16 a[6:7], v20 offset:25344
    v_mfma_f32_16x16x32_bf16 v[104:107], a[20:23], a[52:55], v[104:107]
    v_mfma_f32_16x16x32_bf16 v[108:111], a[20:23], a[56:59], v[108:111]
    v_mfma_f32_16x16x32_bf16 v[112:115], a[20:23], a[60:63], v[112:115]
    v_mfma_f32_16x16x32_bf16 v[116:119], a[20:23], a[64:67], v[116:119]
    s_waitcnt lgkmcnt(2)
    v_mfma_f32_16x16x32_bf16 a[92:95], a[32:35], a[68:71], a[92:95]
    buffer_load_dwordx4 v8, s[28:31], s49 offen offset:1024 lds
    ds_read_b64_tr_b16 a[8:9], v21 offset:24576
    ds_read_b64_tr_b16 a[10:11], v21 offset:25344
    ds_read_b64_tr_b16 a[36:37], v23 offset:16384
    ds_read_b64_tr_b16 a[38:39], v23 offset:17408
    v_mfma_f32_16x16x32_bf16 v[120:123], a[24:27], a[52:55], v[120:123]
    v_mfma_f32_16x16x32_bf16 v[124:127], a[24:27], a[56:59], v[124:127]
    v_mfma_f32_16x16x32_bf16 v[128:131], a[24:27], a[60:63], v[128:131]
    v_mfma_f32_16x16x32_bf16 v[132:135], a[24:27], a[64:67], v[132:135]
    v_mfma_f32_16x16x32_bf16 a[116:119], a[56:59], a[56:59], a[116:119]
    buffer_load_dwordx4 v9, s[28:31], s49 offen offset:2048 lds
    ds_read_b64_tr_b16 a[12:13], v19 offset:30720
    ds_read_b64_tr_b16 a[14:15], v19 offset:31488
    v_mfma_f32_16x16x32_bf16 v[136:139], a[28:31], a[52:55], v[136:139]
    v_mfma_f32_16x16x32_bf16 v[140:143], a[28:31], a[56:59], v[140:143]
    v_mfma_f32_16x16x32_bf16 v[144:147], a[28:31], a[60:63], v[144:147]
    v_mfma_f32_16x16x32_bf16 v[148:151], a[28:31], a[64:67], v[148:151]
    s_waitcnt lgkmcnt(2)
    v_mfma_f32_16x16x32_bf16 a[96:99], a[36:39], a[68:71], a[96:99]
    s_add_u32 m0, s51, 8192
    s_mov_b64 exec, s[44:45]
    buffer_load_dwordx4 v5, s[24:27], s48 offen offset:0 lds
    buffer_load_dwordx4 v6, s[24:27], s48 offen offset:1024 lds
    s_mov_b64 exec, -1
    ds_read_b64_tr_b16 a[16:17], v20 offset:30720
    ds_read_b64_tr_b16 a[18:19], v20 offset:31488
    ds_read_b64_tr_b16 a[40:41], v24 offset:24576
    ds_read_b64_tr_b16 a[42:43], v24 offset:25344
    v_mfma_f32_16x16x32_bf16 v[152:155], a[0:3], a[52:55], v[152:155]
    v_mfma_f32_16x16x32_bf16 v[156:159], a[0:3], a[56:59], v[156:159]
    ds_read_b128 a[72:75], v249 offset:18432
    v_mfma_f32_16x16x32_bf16 v[160:163], a[0:3], a[60:63], v[160:163]
    v_mfma_f32_16x16x32_bf16 v[164:167], a[0:3], a[64:67], v[164:167]
    v_mfma_f32_16x16x32_bf16 a[120:123], a[68:71], a[68:71], a[120:123]
    ds_read_b64_tr_b16 a[20:21], v21 offset:30720
    ds_read_b64_tr_b16 a[22:23], v21 offset:31488
    v_mfma_f32_16x16x32_bf16 v[168:171], a[4:7], a[52:55], v[168:171]
    v_mfma_f32_16x16x32_bf16 v[172:175], a[4:7], a[56:59], v[172:175]
    ds_read_b128 a[76:79], v249 offset:20480
    v_mfma_f32_16x16x32_bf16 v[176:179], a[4:7], a[60:63], v[176:179]
    v_mfma_f32_16x16x32_bf16 v[180:183], a[4:7], a[64:67], v[180:183]
    s_waitcnt lgkmcnt(4)
    v_mfma_f32_16x16x32_bf16 a[100:103], a[40:43], a[68:71], a[100:103]
    ds_read_b64_tr_b16 a[24:25], v15 offset:24576
    ds_read_b64_tr_b16 a[26:27], v15 offset:25600
    ds_read_b64_tr_b16 a[44:45], v25 offset:24576
    ds_read_b64_tr_b16 a[46:47], v25 offset:25344
    v_mfma_f32_16x16x32_bf16 v[184:187], a[8:11], a[52:55], v[184:187]
    v_mfma_f32_16x16x32_bf16 v[188:191], a[8:11], a[56:59], v[188:191]
    ds_read_b128 a[80:83], v251 offset:18432
    v_mfma_f32_16x16x32_bf16 v[192:195], a[8:11], a[60:63], v[192:195]
    v_mfma_f32_16x16x32_bf16 v[196:199], a[8:11], a[64:67], v[196:199]
    ds_read_b64_tr_b16 a[28:29], v16 offset:24576
    ds_read_b64_tr_b16 a[30:31], v16 offset:25600
    v_mfma_f32_16x16x32_bf16 v[200:203], a[12:15], a[52:55], v[200:203]
    v_mfma_f32_16x16x32_bf16 v[204:207], a[12:15], a[56:59], v[204:207]
    ds_read_b128 a[84:87], v251 offset:20480
    v_mfma_f32_16x16x32_bf16 v[208:211], a[12:15], a[60:63], v[208:211]
    v_mfma_f32_16x16x32_bf16 v[212:215], a[12:15], a[64:67], v[212:215]
    s_waitcnt lgkmcnt(4)
    v_mfma_f32_16x16x32_bf16 a[104:107], a[44:47], a[68:71], a[104:107]
    ds_read_b64_tr_b16 a[0:1], v17 offset:24576
    ds_read_b64_tr_b16 a[2:3], v17 offset:25600
    ds_read_b64_tr_b16 a[48:49], v26 offset:24576
    ds_read_b64_tr_b16 a[50:51], v26 offset:25344
    v_mfma_f32_16x16x32_bf16 v[216:219], a[16:19], a[52:55], v[216:219]
    v_mfma_f32_16x16x32_bf16 v[220:223], a[16:19], a[56:59], v[220:223]
    ds_read_b128 a[88:91], v253 offset:18432
    v_mfma_f32_16x16x32_bf16 v[224:227], a[16:19], a[60:63], v[224:227]
    v_mfma_f32_16x16x32_bf16 v[228:231], a[16:19], a[64:67], v[228:231]
    ds_read_b64_tr_b16 a[4:5], v18 offset:24576
    ds_read_b64_tr_b16 a[6:7], v18 offset:25600
    v_mfma_f32_16x16x32_bf16 v[232:235], a[20:23], a[52:55], v[232:235]
    v_mfma_f32_16x16x32_bf16 v[236:239], a[20:23], a[56:59], v[236:239]
    v_mfma_f32_16x16x32_bf16 v[240:243], a[20:23], a[60:63], v[240:243]
    v_mfma_f32_16x16x32_bf16 v[244:247], a[20:23], a[64:67], v[244:247]
    s_waitcnt lgkmcnt(3)
    v_mfma_f32_16x16x32_bf16 a[108:111], a[48:51], a[68:71], a[108:111]
    s_waitcnt vmcnt(12)
    s_barrier
    ds_read_b64_tr_b16 a[8:9], v19 offset:36864
    ds_read_b64_tr_b16 a[10:11], v19 offset:37632
    ds_read_b64_tr_b16 a[32:33], v22 offset:24576
    ds_read_b64_tr_b16 a[34:35], v22 offset:25600
    s_waitcnt lgkmcnt(6)
    v_mfma_f32_16x16x32_bf16 v[88:91], a[24:27], a[72:75], v[88:91]
    v_mfma_f32_16x16x32_bf16 v[92:95], a[24:27], a[76:79], v[92:95]
    s_mov_b64 exec, s[92:93]
    buffer_load_dwordx4 v[54:57], v52, s[64:67], 0 offen sc1
    s_mov_b64 exec, -1
    v_mfma_f32_16x16x32_bf16 v[96:99], a[24:27], a[80:83], v[96:99]
    v_mfma_f32_16x16x32_bf16 v[100:103], a[24:27], a[84:87], v[100:103]
    v_mfma_f32_16x16x32_bf16 a[112:115], a[72:75], a[72:75], a[112:115]
    s_add_u32 m0, s52, 24576
    s_mul_i32 s49, s10, 98304
    s_mul_i32 s48, s10, 122880
    s_add_u32 s10, s10, 1
    s_cmp_eq_u32 s10, 20
    s_cselect_b32 s10, 0, s10
    buffer_load_dwordx4 v7, s[28:31], s49 offen offset:0 lds
    ds_read_b64_tr_b16 a[12:13], v20 offset:36864
    ds_read_b64_tr_b16 a[14:15], v20 offset:37632
    v_mfma_f32_16x16x32_bf16 v[104:107], a[28:31], a[72:75], v[104:107]
    v_mfma_f32_16x16x32_bf16 v[108:111], a[28:31], a[76:79], v[108:111]
    v_mfma_f32_16x16x32_bf16 v[112:115], a[28:31], a[80:83], v[112:115]
    v_mfma_f32_16x16x32_bf16 v[116:119], a[28:31], a[84:87], v[116:119]
    s_waitcnt lgkmcnt(2)
    v_mfma_f32_16x16x32_bf16 a[92:95], a[32:35], a[88:91], a[92:95]
    buffer_load_dwordx4 v8, s[28:31], s49 offen offset:1024 lds
    ds_read_b64_tr_b16 a[16:17], v21 offset:36864
    ds_read_b64_tr_b16 a[18:19], v21 offset:37632
    ds_read_b64_tr_b16 a[36:37], v23 offset:24576
    ds_read_b64_tr_b16 a[38:39], v23 offset:25600
    v_mfma_f32_16x16x32_bf16 v[120:123], a[0:3], a[72:75], v[120:123]
    v_mfma_f32_16x16x32_bf16 v[124:127], a[0:3], a[76:79], v[124:127]
    v_mfma_f32_16x16x32_bf16 v[128:131], a[0:3], a[80:83], v[128:131]
    v_mfma_f32_16x16x32_bf16 v[132:135], a[0:3], a[84:87], v[132:135]
    v_mfma_f32_16x16x32_bf16 a[116:119], a[76:79], a[76:79], a[116:119]
    buffer_load_dwordx4 v9, s[28:31], s49 offen offset:2048 lds
    ds_read_b64_tr_b16 a[20:21], v19 offset:43008
    ds_read_b64_tr_b16 a[22:23], v19 offset:43776
    v_mfma_f32_16x16x32_bf16 v[136:139], a[4:7], a[72:75], v[136:139]
    v_mfma_f32_16x16x32_bf16 v[140:143], a[4:7], a[76:79], v[140:143]
    v_mfma_f32_16x16x32_bf16 v[144:147], a[4:7], a[80:83], v[144:147]
    v_mfma_f32_16x16x32_bf16 v[148:151], a[4:7], a[84:87], v[148:151]
    s_waitcnt lgkmcnt(2)
    v_mfma_f32_16x16x32_bf16 a[96:99], a[36:39], a[88:91], a[96:99]
    s_add_u32 m0, s51, 16384
    s_mov_b64 exec, s[44:45]
    buffer_load_dwordx4 v5, s[24:27], s48 offen offset:0 lds
    buffer_load_dwordx4 v6, s[24:27], s48 offen offset:1024 lds
    s_mov_b64 exec, -1
    ds_read_b64_tr_b16 a[24:25], v20 offset:43008
    ds_read_b64_tr_b16 a[26:27], v20 offset:43776
    ds_read_b64_tr_b16 a[40:41], v24 offset:36864
    ds_read_b64_tr_b16 a[42:43], v24 offset:37632
    v_mfma_f32_16x16x32_bf16 v[152:155], a[8:11], a[72:75], v[152:155]
    v_mfma_f32_16x16x32_bf16 v[156:159], a[8:11], a[76:79], v[156:159]
    ds_read_b128 a[52:55], v248 offset:36864
    v_mfma_f32_16x16x32_bf16 v[160:163], a[8:11], a[80:83], v[160:163]
    v_mfma_f32_16x16x32_bf16 v[164:167], a[8:11], a[84:87], v[164:167]
    v_mfma_f32_16x16x32_bf16 a[120:123], a[88:91], a[88:91], a[120:123]
    s_add_u32 m0, s53, 18432
    s_mov_b32 s72, s11
    s_add_u32 s11, s11, 128
    s_cmp_eq_u32 s11, 1280
    s_cselect_b32 s11, 0, s11
    buffer_load_dwordx4 v10, s[20:23], s72 offen offset:0 lds
    ds_read_b64_tr_b16 a[28:29], v21 offset:43008
    ds_read_b64_tr_b16 a[30:31], v21 offset:43776
    v_mfma_f32_16x16x32_bf16 v[168:171], a[12:15], a[72:75], v[168:171]
    v_mfma_f32_16x16x32_bf16 v[172:175], a[12:15], a[76:79], v[172:175]
    ds_read_b128 a[56:59], v248 offset:38912
    v_mfma_f32_16x16x32_bf16 v[176:179], a[12:15], a[80:83], v[176:179]
    v_mfma_f32_16x16x32_bf16 v[180:183], a[12:15], a[84:87], v[180:183]
    s_waitcnt lgkmcnt(4)
    v_mfma_f32_16x16x32_bf16 a[100:103], a[40:43], a[88:91], a[100:103]
    buffer_load_dwordx4 v11, s[20:23], s72 offen offset:1024 lds
    ds_read_b64_tr_b16 a[0:1], v15 offset:0
    ds_read_b64_tr_b16 a[2:3], v15 offset:1024
    ds_read_b64_tr_b16 a[44:45], v25 offset:36864
    ds_read_b64_tr_b16 a[46:47], v25 offset:37632
    v_mfma_f32_16x16x32_bf16 v[184:187], a[16:19], a[72:75], v[184:187]
    v_mfma_f32_16x16x32_bf16 v[188:191], a[16:19], a[76:79], v[188:191]
    ds_read_b128 a[60:63], v250 offset:36864
    v_mfma_f32_16x16x32_bf16 v[192:195], a[16:19], a[80:83], v[192:195]
    v_mfma_f32_16x16x32_bf16 v[196:199], a[16:19], a[84:87], v[196:199]
    buffer_load_dwordx4 v12, s[20:23], s72 offen offset:2048 lds
    ds_read_b64_tr_b16 a[4:5], v16 offset:0
    ds_read_b64_tr_b16 a[6:7], v16 offset:1024
    v_mfma_f32_16x16x32_bf16 v[200:203], a[20:23], a[72:75], v[200:203]
    v_mfma_f32_16x16x32_bf16 v[204:207], a[20:23], a[76:79], v[204:207]
    ds_read_b128 a[64:67], v250 offset:38912
    v_mfma_f32_16x16x32_bf16 v[208:211], a[20:23], a[80:83], v[208:211]
    v_mfma_f32_16x16x32_bf16 v[212:215], a[20:23], a[84:87], v[212:215]
    s_waitcnt lgkmcnt(4)
    v_mfma_f32_16x16x32_bf16 a[104:107], a[44:47], a[88:91], a[104:107]
    buffer_load_dwordx4 v13, s[20:23], s72 offen offset:3072 lds
    ds_read_b64_tr_b16 a[8:9], v17 offset:0
    ds_read_b64_tr_b16 a[10:11], v17 offset:1024
    ds_read_b64_tr_b16 a[48:49], v26 offset:36864
    ds_read_b64_tr_b16 a[50:51], v26 offset:37632
    v_mfma_f32_16x16x32_bf16 v[216:219], a[24:27], a[72:75], v[216:219]
    v_mfma_f32_16x16x32_bf16 v[220:223], a[24:27], a[76:79], v[220:223]
    ds_read_b128 a[68:71], v252 offset:36864
    v_mfma_f32_16x16x32_bf16 v[224:227], a[24:27], a[80:83], v[224:227]
    v_mfma_f32_16x16x32_bf16 v[228:231], a[24:27], a[84:87], v[228:231]
    s_add_u32 m0, s50, 18432
    s_mov_b64 exec, s[46:47]
    buffer_load_dwordx4 v14, s[20:23], s72 offen lds
    s_mov_b64 exec, -1
    ds_read_b64_tr_b16 a[12:13], v18 offset:0
    ds_read_b64_tr_b16 a[14:15], v18 offset:1024
    v_mfma_f32_16x16x32_bf16 v[232:235], a[28:31], a[72:75], v[232:235]
    v_mfma_f32_16x16x32_bf16 v[236:239], a[28:31], a[76:79], v[236:239]
    v_mfma_f32_16x16x32_bf16 v[240:243], a[28:31], a[80:83], v[240:243]
    v_mfma_f32_16x16x32_bf16 v[244:247], a[28:31], a[84:87], v[244:247]
    s_waitcnt lgkmcnt(3)
    v_mfma_f32_16x16x32_bf16 a[108:111], a[48:51], a[88:91], a[108:111]
    s_waitcnt vmcnt(11)
    s_barrier
    ds_read_b64_tr_b16 a[16:17], v19 offset:0
    ds_read_b64_tr_b16 a[18:19], v19 offset:768
    ds_read_b64_tr_b16 a[32:33], v22 offset:0
    ds_read_b64_tr_b16 a[34:35], v22 offset:1024
    s_waitcnt lgkmcnt(6)
    v_mfma_f32_16x16x32_bf16 v[88:91], a[0:3], a[52:55], v[88:91]
    v_mfma_f32_16x16x32_bf16 v[92:95], a[0:3], a[56:59], v[92:95]
    v_mfma_f32_16x16x32_bf16 v[96:99], a[0:3], a[60:63], v[96:99]
    v_mfma_f32_16x16x32_bf16 v[100:103], a[0:3], a[64:67], v[100:103]
    v_mfma_f32_16x16x32_bf16 a[112:115], a[52:55], a[52:55], a[112:115]
    s_add_u32 m0, s52, 36864
    s_mul_i32 s49, s10, 98304
    s_mul_i32 s48, s10, 122880
    s_add_u32 s10, s10, 1
    s_cmp_eq_u32 s10, 20
    s_cselect_b32 s10, 0, s10
    buffer_load_dwordx4 v7, s[28:31], s49 offen offset:0 lds
    ds_read_b64_tr_b16 a[20:21], v20 offset:0
    ds_read_b64_tr_b16 a[22:23], v20 offset:768
    v_mfma_f32_16x16x32_bf16 v[104:107], a[4:7], a[52:55], v[104:107]
    v_mfma_f32_16x16x32_bf16 v[108:111], a[4:7], a[56:59], v[108:111]
    v_mfma_f32_16x16x32_bf16 v[112:115], a[4:7], a[60:63], v[112:115]
    v_mfma_f32_16x16x32_bf16 v[116:119], a[4:7], a[64:67], v[116:119]
    s_waitcnt lgkmcnt(2)
    v_mfma_f32_16x16x32_bf16 a[92:95], a[32:35], a[68:71], a[92:95]
    buffer_load_dwordx4 v8, s[28:31], s49 offen offset:1024 lds
    ds_read_b64_tr_b16 a[24:25], v21 offset:0
    ds_read_b64_tr_b16 a[26:27], v21 offset:768
    ds_read_b64_tr_b16 a[36:37], v23 offset:0
    ds_read_b64_tr_b16 a[38:39], v23 offset:1024
    v_mfma_f32_16x16x32_bf16 v[120:123], a[8:11], a[52:55], v[120:123]
    v_mfma_f32_16x16x32_bf16 v[124:127], a[8:11], a[56:59], v[124:127]
    v_mfma_f32_16x16x32_bf16 v[128:131], a[8:11], a[60:63], v[128:131]
    v_mfma_f32_16x16x32_bf16 v[132:135], a[8:11], a[64:67], v[132:135]
    v_mfma_f32_16x16x32_bf16 a[116:119], a[56:59], a[56:59], a[116:119]
    buffer_load_dwordx4 v9, s[28:31], s49 offen offset:2048 lds
    ds_read_b64_tr_b16 a[28:29], v19 offset:6144
    ds_read_b64_tr_b16 a[30:31], v19 offset:6912
    v_mfma_f32_16x16x32_bf16 v[136:139], a[12:15], a[52:55], v[136:139]
    v_mfma_f32_16x16x32_bf16 v[140:143], a[12:15], a[56:59], v[140:143]
    v_mfma_f32_16x16x32_bf16 v[144:147], a[12:15], a[60:63], v[144:147]
    v_mfma_f32_16x16x32_bf16 v[148:151], a[12:15], a[64:67], v[148:151]
    s_waitcnt lgkmcnt(2)
    v_mfma_f32_16x16x32_bf16 a[96:99], a[36:39], a[68:71], a[96:99]
    s_add_u32 m0, s51, 24576
    s_mov_b64 exec, s[44:45]
    buffer_load_dwordx4 v5, s[24:27], s48 offen offset:0 lds
    buffer_load_dwordx4 v6, s[24:27], s48 offen offset:1024 lds
    s_mov_b64 exec, -1
    ds_read_b64_tr_b16 a[0:1], v20 offset:6144
    ds_read_b64_tr_b16 a[2:3], v20 offset:6912
    ds_read_b64_tr_b16 a[40:41], v24 offset:0
    ds_read_b64_tr_b16 a[42:43], v24 offset:768
    v_mfma_f32_16x16x32_bf16 v[152:155], a[16:19], a[52:55], v[152:155]
    v_mfma_f32_16x16x32_bf16 v[156:159], a[16:19], a[56:59], v[156:159]
    ds_read_b128 a[72:75], v249 offset:36864
    v_mfma_f32_16x16x32_bf16 v[160:163], a[16:19], a[60:63], v[160:163]
    v_mfma_f32_16x16x32_bf16 v[164:167], a[16:19], a[64:67], v[164:167]
    v_mfma_f32_16x16x32_bf16 a[120:123], a[68:71], a[68:71], a[120:123]
    ds_read_b64_tr_b16 a[4:5], v21 offset:6144
    ds_read_b64_tr_b16 a[6:7], v21 offset:6912
    v_mfma_f32_16x16x32_bf16 v[168:171], a[20:23], a[52:55], v[168:171]
    v_mfma_f32_16x16x32_bf16 v[172:175], a[20:23], a[56:59], v[172:175]
    ds_read_b128 a[76:79], v249 offset:38912
    v_mfma_f32_16x16x32_bf16 v[176:179], a[20:23], a[60:63], v[176:179]
    v_mfma_f32_16x16x32_bf16 v[180:183], a[20:23], a[64:67], v[180:183]
    s_waitcnt lgkmcnt(4)
    v_mfma_f32_16x16x32_bf16 a[100:103], a[40:43], a[68:71], a[100:103]
    ds_read_b64_tr_b16 a[8:9], v15 offset:8192
    ds_read_b64_tr_b16 a[10:11], v15 offset:9216
    ds_read_b64_tr_b16 a[44:45], v25 offset:0
    ds_read_b64_tr_b16 a[46:47], v25 offset:768
    v_mfma_f32_16x16x32_bf16 v[184:187], a[24:27], a[52:55], v[184:187]
    v_mfma_f32_16x16x32_bf16 v[188:191], a[24:27], a[56:59], v[188:191]
    ds_read_b128 a[80:83], v251 offset:36864
    v_mfma_f32_16x16x32_bf16 v[192:195], a[24:27], a[60:63], v[192:195]
    v_mfma_f32_16x16x32_bf16 v[196:199], a[24:27], a[64:67], v[196:199]
    ds_read_b64_tr_b16 a[12:13], v16 offset:8192
    ds_read_b64_tr_b16 a[14:15], v16 offset:9216
    v_mfma_f32_16x16x32_bf16 v[200:203], a[28:31], a[52:55], v[200:203]
    v_mfma_f32_16x16x32_bf16 v[204:207], a[28:31], a[56:59], v[204:207]
    ds_read_b128 a[84:87], v251 offset:38912
    v_mfma_f32_16x16x32_bf16 v[208:211], a[28:31], a[60:63], v[208:211]
    v_mfma_f32_16x16x32_bf16 v[212:215], a[28:31], a[64:67], v[212:215]
    s_waitcnt lgkmcnt(4)
    v_mfma_f32_16x16x32_bf16 a[104:107], a[44:47], a[68:71], a[104:107]
    ds_read_b64_tr_b16 a[16:17], v17 offset:8192
    ds_read_b64_tr_b16 a[18:19], v17 offset:9216
    ds_read_b64_tr_b16 a[48:49], v26 offset:0
    ds_read_b64_tr_b16 a[50:51], v26 offset:768
    v_mfma_f32_16x16x32_bf16 v[216:219], a[0:3], a[52:55], v[216:219]
    v_mfma_f32_16x16x32_bf16 v[220:223], a[0:3], a[56:59], v[220:223]
    ds_read_b128 a[88:91], v253 offset:36864
    v_mfma_f32_16x16x32_bf16 v[224:227], a[0:3], a[60:63], v[224:227]
    v_mfma_f32_16x16x32_bf16 v[228:231], a[0:3], a[64:67], v[228:231]
    ds_read_b64_tr_b16 a[20:21], v18 offset:8192
    ds_read_b64_tr_b16 a[22:23], v18 offset:9216
    v_mfma_f32_16x16x32_bf16 v[232:235], a[4:7], a[52:55], v[232:235]
    v_mfma_f32_16x16x32_bf16 v[236:239], a[4:7], a[56:59], v[236:239]
    v_mfma_f32_16x16x32_bf16 v[240:243], a[4:7], a[60:63], v[240:243]
    v_mfma_f32_16x16x32_bf16 v[244:247], a[4:7], a[64:67], v[244:247]
    s_waitcnt lgkmcnt(3)
    v_mfma_f32_16x16x32_bf16 a[108:111], a[48:51], a[68:71], a[108:111]
    s_waitcnt vmcnt(10)
    s_barrier
    ds_read_b64_tr_b16 a[24:25], v19 offset:12288
    ds_read_b64_tr_b16 a[26:27], v19 offset:13056
    ds_read_b64_tr_b16 a[32:33], v22 offset:8192
    ds_read_b64_tr_b16 a[34:35], v22 offset:9216
    s_waitcnt lgkmcnt(6)
    v_mfma_f32_16x16x32_bf16 v[88:91], a[8:11], a[72:75], v[88:91]
    v_mfma_f32_16x16x32_bf16 v[92:95], a[8:11], a[76:79], v[92:95]
    s_cmp_eq_u32 s98, 0
    s_cbranch_scc1 k1_hs0
    v_mov_b32 v58, v54
    v_mov_b32 v59, v55
    v_mov_b32 v60, v56
    v_mov_b32 v61, v57
k1_hs0:
    s_mov_b64 exec, s[92:93]
    buffer_store_dwordx4 v[58:61], v53, s[64:67], 0 offen sc1
    s_mov_b64 exec, -1
    v_mfma_f32_16x16x32_bf16 v[96:99], a[8:11], a[80:83], v[96:99]
    v_mfma_f32_16x16x32_bf16 v[100:103], a[8:11], a[84:87], v[100:103]
    v_mfma_f32_16x16x32_bf16 a[112:115], a[72:75], a[72:75], a[112:115]
    s_add_u32 m0, s52, 0
    s_mul_i32 s49, s10, 98304
    s_mul_i32 s48, s10, 122880
    s_add_u32 s10, s10, 1
    s_cmp_eq_u32 s10, 20
    s_cselect_b32 s10, 0, s10
    buffer_load_dwordx4 v7, s[28:31], s49 offen offset:0 lds
    ds_read_b64_tr_b16 a[28:29], v20 offset:12288
    ds_read_b64_tr_b16 a[30:31], v20 offset:13056
    v_mfma_f32_16x16x32_bf16 v[104:107], a[12:15], a[72:75], v[104:107]
    v_mfma_f32_16x16x32_bf16 v[108:111], a[12:15], a[76:79], v[108:111]
    v_mfma_f32_16x16x32_bf16 v[112:115], a[12:15], a[80:83], v[112:115]
    v_mfma_f32_16x16x32_bf16 v[116:119], a[12:15], a[84:87], v[116:119]
    s_waitcnt lgkmcnt(2)
    v_mfma_f32_16x16x32_bf16 a[92:95], a[32:35], a[88:91], a[92:95]
    buffer_load_dwordx4 v8, s[28:31], s49 offen offset:1024 lds
    ds_read_b64_tr_b16 a[0:1], v21 offset:12288
    ds_read_b64_tr_b16 a[2:3], v21 offset:13056
    ds_read_b64_tr_b16 a[36:37], v23 offset:8192
    ds_read_b64_tr_b16 a[38:39], v23 offset:9216
    v_mfma_f32_16x16x32_bf16 v[120:123], a[16:19], a[72:75], v[120:123]
    v_mfma_f32_16x16x32_bf16 v[124:127], a[16:19], a[76:79], v[124:127]
    v_mfma_f32_16x16x32_bf16 v[128:131], a[16:19], a[80:83], v[128:131]
    v_mfma_f32_16x16x32_bf16 v[132:135], a[16:19], a[84:87], v[132:135]
    v_mfma_f32_16x16x32_bf16 a[116:119], a[76:79], a[76:79], a[116:119]
    buffer_load_dwordx4 v9, s[28:31], s49 offen offset:2048 lds
    ds_read_b64_tr_b16 a[4:5], v19 offset:18432
    ds_read_b64_tr_b16 a[6:7], v19 offset:19200
    v_mfma_f32_16x16x32_bf16 v[136:139], a[20:23], a[72:75], v[136:139]
    v_mfma_f32_16x16x32_bf16 v[140:143], a[20:23], a[76:79], v[140:143]
    v_mfma_f32_16x16x32_bf16 v[144:147], a[20:23], a[80:83], v[144:147]
    v_mfma_f32_16x16x32_bf16 v[148:151], a[20:23], a[84:87], v[148:151]
    s_waitcnt lgkmcnt(2)
    v_mfma_f32_16x16x32_bf16 a[96:99], a[36:39], a[88:91], a[96:99]
    s_add_u32 m0, s51, 0
    s_mov_b64 exec, s[44:45]
    buffer_load_dwordx4 v5, s[24:27], s48 offen offset:0 lds
    buffer_load_dwordx4 v6, s[24:27], s48 offen offset:1024 lds
    s_mov_b64 exec, -1
    ds_read_b64_tr_b16 a[8:9], v20 offset:18432
    ds_read_b64_tr_b16 a[10:11], v20 offset:19200
    ds_read_b64_tr_b16 a[40:41], v24 offset:12288
    ds_read_b64_tr_b16 a[42:43], v24 offset:13056
    v_mfma_f32_16x16x32_bf16 v[152:155], a[24:27], a[72:75], v[152:155]
    v_mfma_f32_16x16x32_bf16 v[156:159], a[24:27], a[76:79], v[156:159]
    ds_read_b128 a[52:55], v248 offset:0
    v_mfma_f32_16x16x32_bf16 v[160:163], a[24:27], a[80:83], v[160:163]
    v_mfma_f32_16x16x32_bf16 v[164:167], a[24:27], a[84:87], v[164:167]
    v_mfma_f32_16x16x32_bf16 a[120:123], a[88:91], a[88:91], a[120:123]
    s_add_u32 m0, s53, 36864
    s_mov_b32 s72, s11
    s_add_u32 s11, s11, 128
    s_cmp_eq_u32 s11, 1280
    s_cselect_b32 s11, 0, s11
    buffer_load_dwordx4 v10, s[20:23], s72 offen offset:0 lds
    ds_read_b64_tr_b16 a[12:13], v21 offset:18432
    ds_read_b64_tr_b16 a[14:15], v21 offset:19200
    v_mfma_f32_16x16x32_bf16 v[168:171], a[28:31], a[72:75], v[168:171]
    v_mfma_f32_16x16x32_bf16 v[172:175], a[28:31], a[76:79], v[172:175]
    ds_read_b128 a[56:59], v248 offset:2048
    v_mfma_f32_16x16x32_bf16 v[176:179], a[28:31], a[80:83], v[176:179]
    v_mfma_f32_16x16x32_bf16 v[180:183], a[28:31], a[84:87], v[180:183]
    s_waitcnt lgkmcnt(4)
    v_mfma_f32_16x16x32_bf16 a[100:103], a[40:43], a[88:91], a[100:103]
    buffer_load_dwordx4 v11, s[20:23], s72 offen offset:1024 lds
    ds_read_b64_tr_b16 a[16:17], v15 offset:16384
    ds_read_b64_tr_b16 a[18:19], v15 offset:17408
    ds_read_b64_tr_b16 a[44:45], v25 offset:12288
    ds_read_b64_tr_b16 a[46:47], v25 offset:13056
    v_mfma_f32_16x16x32_bf16 v[184:187], a[0:3], a[72:75], v[184:187]
    v_mfma_f32_16x16x32_bf16 v[188:191], a[0:3], a[76:79], v[188:191]
    ds_read_b128 a[60:63], v250 offset:0
    v_mfma_f32_16x16x32_bf16 v[192:195], a[0:3], a[80:83], v[192:195]
    v_mfma_f32_16x16x32_bf16 v[196:199], a[0:3], a[84:87], v[196:199]
    buffer_load_dwordx4 v12, s[20:23], s72 offen offset:2048 lds
    ds_read_b64_tr_b16 a[20:21], v16 offset:16384
    ds_read_b64_tr_b16 a[22:23], v16 offset:17408
    v_mfma_f32_16x16x32_bf16 v[200:203], a[4:7], a[72:75], v[200:203]
    v_mfma_f32_16x16x32_bf16 v[204:207], a[4:7], a[76:79], v[204:207]
    ds_read_b128 a[64:67], v250 offset:2048
    v_mfma_f32_16x16x32_bf16 v[208:211], a[4:7], a[80:83], v[208:211]
    v_mfma_f32_16x16x32_bf16 v[212:215], a[4:7], a[84:87], v[212:215]
    s_waitcnt lgkmcnt(4)
    v_mfma_f32_16x16x32_bf16 a[104:107], a[44:47], a[88:91], a[104:107]
    buffer_load_dwordx4 v13, s[20:23], s72 offen offset:3072 lds
    ds_read_b64_tr_b16 a[24:25], v17 offset:16384
    ds_read_b64_tr_b16 a[26:27], v17 offset:17408
    ds_read_b64_tr_b16 a[48:49], v26 offset:12288
    ds_read_b64_tr_b16 a[50:51], v26 offset:13056
    v_mfma_f32_16x16x32_bf16 v[216:219], a[8:11], a[72:75], v[216:219]
    v_mfma_f32_16x16x32_bf16 v[220:223], a[8:11], a[76:79], v[220:223]
    ds_read_b128 a[68:71], v252 offset:0
    v_mfma_f32_16x16x32_bf16 v[224:227], a[8:11], a[80:83], v[224:227]
    v_mfma_f32_16x16x32_bf16 v[228:231], a[8:11], a[84:87], v[228:231]
    s_add_u32 m0, s50, 36864
    s_mov_b64 exec, s[46:47]
    buffer_load_dwordx4 v14, s[20:23], s72 offen lds
    s_mov_b64 exec, -1
    ds_read_b64_tr_b16 a[28:29], v18 offset:16384
    ds_read_b64_tr_b16 a[30:31], v18 offset:17408
    v_mfma_f32_16x16x32_bf16 v[232:235], a[12:15], a[72:75], v[232:235]
    v_mfma_f32_16x16x32_bf16 v[236:239], a[12:15], a[76:79], v[236:239]
    v_mfma_f32_16x16x32_bf16 v[240:243], a[12:15], a[80:83], v[240:243]
    v_mfma_f32_16x16x32_bf16 v[244:247], a[12:15], a[84:87], v[244:247]
    s_waitcnt lgkmcnt(3)
    v_mfma_f32_16x16x32_bf16 a[108:111], a[48:51], a[88:91], a[108:111]
    s_waitcnt vmcnt(11)
    s_barrier
    ds_read_b64_tr_b16 a[0:1], v19 offset:24576
    ds_read_b64_tr_b16 a[2:3], v19 offset:25344
    ds_read_b64_tr_b16 a[32:33], v22 offset:16384
    ds_read_b64_tr_b16 a[34:35], v22 offset:17408
    s_waitcnt lgkmcnt(6)
    v_mfma_f32_16x16x32_bf16 v[88:91], a[16:19], a[52:55], v[88:91]
    v_mfma_f32_16x16x32_bf16 v[92:95], a[16:19], a[56:59], v[92:95]
    s_mov_b64 exec, s[92:93]
    buffer_load_dwordx4 v[54:57], v52, s[64:67], 0 offen sc1
    s_mov_b64 exec, -1
    v_mfma_f32_16x16x32_bf16 v[96:99], a[16:19], a[60:63], v[96:99]
    v_mfma_f32_16x16x32_bf16 v[100:103], a[16:19], a[64:67], v[100:103]
    v_mfma_f32_16x16x32_bf16 a[112:115], a[52:55], a[52:55], a[112:115]
    s_add_u32 m0, s52, 12288
    s_mul_i32 s49, s10, 98304
    s_mul_i32 s48, s10, 122880
    s_add_u32 s10, s10, 1
    s_cmp_eq_u32 s10, 20
    s_cselect_b32 s10, 0, s10
    buffer_load_dwordx4 v7, s[28:31], s49 offen offset:0 lds
    ds_read_b64_tr_b16 a[4:5], v20 offset:24576
    ds_read_b64_tr_b16 a[6:7], v20 offset:25344
    v_mfma_f32_16x16x32_bf16 v[104:107], a[20:23], a[52:55], v[104:107]
    v_mfma_f32_16x16x32_bf16 v[108:111], a[20:23], a[56:59], v[108:111]
    ds_read_b64_tr_b16 v[68:69], v67 offset:0
    ds_read_b64_tr_b16 v[70:71], v67 offset:640
    v_mfma_f32_16x16x32_bf16 v[112:115], a[20:23], a[60:63], v[112:115]
    v_mfma_f32_16x16x32_bf16 v[116:119], a[20:23], a[64:67], v[116:119]
    s_waitcnt lgkmcnt(4)
    v_mfma_f32_16x16x32_bf16 a[92:95], a[32:35], a[68:71], a[92:95]
    buffer_load_dwordx4 v8, s[28:31], s49 offen offset:1024 lds
    ds_read_b64_tr_b16 a[8:9], v21 offset:24576
    ds_read_b64_tr_b16 a[10:11], v21 offset:25344
    ds_read_b64_tr_b16 a[36:37], v23 offset:16384
    ds_read_b64_tr_b16 a[38:39], v23 offset:17408
    v_mfma_f32_16x16x32_bf16 v[120:123], a[24:27], a[52:55], v[120:123]
    v_mfma_f32_16x16x32_bf16 v[124:127], a[24:27], a[56:59], v[124:127]
    ds_read_b64_tr_b16 v[72:73], v67 offset:32
    ds_read_b64_tr_b16 v[74:75], v67 offset:672
    v_mfma_f32_16x16x32_bf16 v[128:131], a[24:27], a[60:63], v[128:131]
    v_mfma_f32_16x16x32_bf16 v[132:135], a[24:27], a[64:67], v[132:135]
    v_mfma_f32_16x16x32_bf16 a[116:119], a[56:59], a[56:59], a[116:119]
    buffer_load_dwordx4 v9, s[28:31], s49 offen offset:2048 lds
    ds_read_b64_tr_b16 a[12:13], v19 offset:30720
    ds_read_b64_tr_b16 a[14:15], v19 offset:31488
    v_mfma_f32_16x16x32_bf16 v[136:139], a[28:31], a[52:55], v[136:139]
    v_mfma_f32_16x16x32_bf16 v[140:143], a[28:31], a[56:59], v[140:143]
    ds_read_b64_tr_b16 v[76:77], v67 offset:64
    ds_read_b64_tr_b16 v[78:79], v67 offset:704
    v_mfma_f32_16x16x32_bf16 v[144:147], a[28:31], a[60:63], v[144:147]
    v_mfma_f32_16x16x32_bf16 v[148:151], a[28:31], a[64:67], v[148:151]
    s_waitcnt lgkmcnt(6)
    v_mfma_f32_16x16x32_bf16 a[96:99], a[36:39], a[68:71], a[96:99]
    s_add_u32 m0, s51, 8192
    s_mov_b64 exec, s[44:45]
    buffer_load_dwordx4 v5, s[24:27], s48 offen offset:0 lds
    buffer_load_dwordx4 v6, s[24:27], s48 offen offset:1024 lds
    s_mov_b64 exec, -1
    ds_read_b64_tr_b16 a[16:17], v20 offset:30720
    ds_read_b64_tr_b16 a[18:19], v20 offset:31488
    ds_read_b64_tr_b16 a[40:41], v24 offset:24576
    ds_read_b64_tr_b16 a[42:43], v24 offset:25344
    v_mfma_f32_16x16x32_bf16 v[152:155], a[0:3], a[52:55], v[152:155]
    v_mfma_f32_16x16x32_bf16 v[156:159], a[0:3], a[56:59], v[156:159]
    ds_read_b64_tr_b16 v[80:81], v67 offset:96
    ds_read_b64_tr_b16 v[82:83], v67 offset:736
    ds_read_b128 a[72:75], v249 offset:0
    v_mfma_f32_16x16x32_bf16 v[160:163], a[0:3], a[60:63], v[160:163]
    v_mfma_f32_16x16x32_bf16 v[164:167], a[0:3], a[64:67], v[164:167]
    v_mfma_f32_16x16x32_bf16 a[120:123], a[68:71], a[68:71], a[120:123]
    ds_read_b64_tr_b16 a[20:21], v21 offset:30720
    ds_read_b64_tr_b16 a[22:23], v21 offset:31488
    v_mfma_f32_16x16x32_bf16 v[168:171], a[4:7], a[52:55], v[168:171]
    v_mfma_f32_16x16x32_bf16 v[172:175], a[4:7], a[56:59], v[172:175]
    ds_read_b64_tr_b16 v[84:85], v67 offset:128
    ds_read_b64_tr_b16 v[86:87], v67 offset:768
    ds_read_b128 a[76:79], v249 offset:2048
    v_mfma_f32_16x16x32_bf16 v[176:179], a[4:7], a[60:63], v[176:179]
    v_mfma_f32_16x16x32_bf16 v[180:183], a[4:7], a[64:67], v[180:183]
    s_waitcnt lgkmcnt(8)
    v_mfma_f32_16x16x32_bf16 a[100:103], a[40:43], a[68:71], a[100:103]
    ds_read_b64_tr_b16 a[24:25], v15 offset:24576
    ds_read_b64_tr_b16 a[26:27], v15 offset:25600
    ds_read_b64_tr_b16 a[44:45], v25 offset:24576
    ds_read_b64_tr_b16 a[46:47], v25 offset:25344
    v_mfma_f32_16x16x32_bf16 v[184:187], a[8:11], a[52:55], v[184:187]
    v_mfma_f32_16x16x32_bf16 v[188:191], a[8:11], a[56:59], v[188:191]
    ds_read_b128 a[80:83], v251 offset:0
    v_mfma_f32_16x16x32_bf16 v[192:195], a[8:11], a[60:63], v[192:195]
    v_mfma_f32_16x16x32_bf16 v[196:199], a[8:11], a[64:67], v[196:199]
    ds_read_b64_tr_b16 a[28:29], v16 offset:24576
    ds_read_b64_tr_b16 a[30:31], v16 offset:25600
    v_mfma_f32_16x16x32_bf16 v[200:203], a[12:15], a[52:55], v[200:203]
    v_mfma_f32_16x16x32_bf16 v[204:207], a[12:15], a[56:59], v[204:207]
    ds_read_b128 a[84:87], v251 offset:2048
    v_mfma_f32_16x16x32_bf16 v[208:211], a[12:15], a[60:63], v[208:211]
    v_mfma_f32_16x16x32_bf16 v[212:215], a[12:15], a[64:67], v[212:215]
    s_waitcnt lgkmcnt(4)
    v_mfma_f32_16x16x32_bf16 a[104:107], a[44:47], a[68:71], a[104:107]
    ds_read_b64_tr_b16 a[0:1], v17 offset:24576
    ds_read_b64_tr_b16 a[2:3], v17 offset:25600
    ds_read_b64_tr_b16 a[48:49], v26 offset:24576
    ds_read_b64_tr_b16 a[50:51], v26 offset:25344
    v_mfma_f32_16x16x32_bf16 v[216:219], a[16:19], a[52:55], v[216:219]
    v_mfma_f32_16x16x32_bf16 v[220:223], a[16:19], a[56:59], v[220:223]
    ds_read_b128 a[88:91], v253 offset:0
    v_mfma_f32_16x16x32_bf16 v[224:227], a[16:19], a[60:63], v[224:227]
    v_mfma_f32_16x16x32_bf16 v[228:231], a[16:19], a[64:67], v[228:231]
    ds_read_b64_tr_b16 a[4:5], v18 offset:24576
    ds_read_b64_tr_b16 a[6:7], v18 offset:25600
    v_mfma_f32_16x16x32_bf16 v[232:235], a[20:23], a[52:55], v[232:235]
    v_mfma_f32_16x16x32_bf16 v[236:239], a[20:23], a[56:59], v[236:239]
    v_mfma_f32_16x16x32_bf16 v[240:243], a[20:23], a[60:63], v[240:243]
    v_mfma_f32_16x16x32_bf16 v[244:247], a[20:23], a[64:67], v[244:247]
    s_waitcnt lgkmcnt(3)
    v_mfma_f32_16x16x32_bf16 a[108:111], a[48:51], a[68:71], a[108:111]
    s_waitcnt vmcnt(11)
    s_barrier
    ds_read_b64_tr_b16 a[8:9], v19 offset:36864
    ds_read_b64_tr_b16 a[10:11], v19 offset:37632
    ds_read_b64_tr_b16 a[32:33], v22 offset:24576
    ds_read_b64_tr_b16 a[34:35], v22 offset:25600
    s_waitcnt lgkmcnt(6)
    v_mfma_f32_16x16x32_bf16 v[88:91], a[24:27], a[72:75], v[88:91]
    v_mfma_f32_16x16x32_bf16 v[92:95], a[24:27], a[76:79], v[92:95]
    buffer_store_dwordx4 v[68:71], v29, s[68:71], 0 offen offset:0 sc1
    v_mfma_f32_16x16x32_bf16 v[96:99], a[24:27], a[80:83], v[96:99]
    v_mfma_f32_16x16x32_bf16 v[100:103], a[24:27], a[84:87], v[100:103]
    v_mfma_f32_16x16x32_bf16 a[112:115], a[72:75], a[72:75], a[112:115]
    s_add_u32 m0, s52, 24576
    s_mul_i32 s49, s10, 98304
    s_mul_i32 s48, s10, 122880
    s_add_u32 s10, s10, 1
    s_cmp_eq_u32 s10, 20
    s_cselect_b32 s10, 0, s10
    buffer_load_dwordx4 v7, s[28:31], s49 offen offset:0 lds
    ds_read_b64_tr_b16 a[12:13], v20 offset:36864
    ds_read_b64_tr_b16 a[14:15], v20 offset:37632
    v_mfma_f32_16x16x32_bf16 v[104:107], a[28:31], a[72:75], v[104:107]
    v_mfma_f32_16x16x32_bf16 v[108:111], a[28:31], a[76:79], v[108:111]
    buffer_store_dwordx4 v[72:75], v29, s[68:71], 0 offen offset:1024 sc1
    v_mfma_f32_16x16x32_bf16 v[112:115], a[28:31], a[80:83], v[112:115]
    v_mfma_f32_16x16x32_bf16 v[116:119], a[28:31], a[84:87], v[116:119]
    s_waitcnt lgkmcnt(2)
    v_mfma_f32_16x16x32_bf16 a[92:95], a[32:35], a[88:91], a[92:95]
    buffer_load_dwordx4 v8, s[28:31], s49 offen offset:1024 lds
    ds_read_b64_tr_b16 a[16:17], v21 offset:36864
    ds_read_b64_tr_b16 a[18:19], v21 offset:37632
    ds_read_b64_tr_b16 a[36:37], v23 offset:24576
    ds_read_b64_tr_b16 a[38:39], v23 offset:25600
    v_mfma_f32_16x16x32_bf16 v[120:123], a[0:3], a[72:75], v[120:123]
    v_mfma_f32_16x16x32_bf16 v[124:127], a[0:3], a[76:79], v[124:127]
    buffer_store_dwordx4 v[76:79], v29, s[68:71], 0 offen offset:2048 sc1
    v_mfma_f32_16x16x32_bf16 v[128:131], a[0:3], a[80:83], v[128:131]
    v_mfma_f32_16x16x32_bf16 v[132:135], a[0:3], a[84:87], v[132:135]
    v_mfma_f32_16x16x32_bf16 a[116:119], a[76:79], a[76:79], a[116:119]
    buffer_load_dwordx4 v9, s[28:31], s49 offen offset:2048 lds
    ds_read_b64_tr_b16 a[20:21], v19 offset:43008
    ds_read_b64_tr_b16 a[22:23], v19 offset:43776
    v_mfma_f32_16x16x32_bf16 v[136:139], a[4:7], a[72:75], v[136:139]
    v_mfma_f32_16x16x32_bf16 v[140:143], a[4:7], a[76:79], v[140:143]
    buffer_store_dwordx4 v[80:83], v29, s[68:71], 0 offen offset:3072 sc1
    v_mfma_f32_16x16x32_bf16 v[144:147], a[4:7], a[80:83], v[144:147]
    v_mfma_f32_16x16x32_bf16 v[148:151], a[4:7], a[84:87], v[148:151]
    s_waitcnt lgkmcnt(2)
    v_mfma_f32_16x16x32_bf16 a[96:99], a[36:39], a[88:91], a[96:99]
    s_add_u32 m0, s51, 16384
    s_mov_b64 exec, s[44:45]
    buffer_load_dwordx4 v5, s[24:27], s48 offen offset:0 lds
    buffer_load_dwordx4 v6, s[24:27], s48 offen offset:1024 lds
    s_mov_b64 exec, -1
    ds_read_b64_tr_b16 a[24:25], v20 offset:43008
    ds_read_b64_tr_b16 a[26:27], v20 offset:43776
    ds_read_b64_tr_b16 a[40:41], v24 offset:36864
    ds_read_b64_tr_b16 a[42:43], v24 offset:37632
    v_mfma_f32_16x16x32_bf16 v[152:155], a[8:11], a[72:75], v[152:155]
    v_mfma_f32_16x16x32_bf16 v[156:159], a[8:11], a[76:79], v[156:159]
    buffer_store_dwordx4 v[84:87], v29, s[68:71], s99 offen sc1
    ds_read_b128 a[52:55], v248 offset:18432
    v_mfma_f32_16x16x32_bf16 v[160:163], a[8:11], a[80:83], v[160:163]
    v_mfma_f32_16x16x32_bf16 v[164:167], a[8:11], a[84:87], v[164:167]
    v_mfma_f32_16x16x32_bf16 a[120:123], a[88:91], a[88:91], a[120:123]
    s_add_u32 m0, s53, 0
    s_mov_b32 s72, s11
    s_add_u32 s11, s11, 128
    s_cmp_eq_u32 s11, 1280
    s_cselect_b32 s11, 0, s11
    buffer_load_dwordx4 v10, s[20:23], s72 offen offset:0 lds
    ds_read_b64_tr_b16 a[28:29], v21 offset:43008
    ds_read_b64_tr_b16 a[30:31], v21 offset:43776
    v_mfma_f32_16x16x32_bf16 v[168:171], a[12:15], a[72:75], v[168:171]
    v_mfma_f32_16x16x32_bf16 v[172:175], a[12:15], a[76:79], v[172:175]
    ds_read_b128 a[56:59], v248 offset:20480
    v_mfma_f32_16x16x32_bf16 v[176:179], a[12:15], a[80:83], v[176:179]
    v_mfma_f32_16x16x32_bf16 v[180:183], a[12:15], a[84:87], v[180:183]
    s_waitcnt lgkmcnt(4)
    v_mfma_f32_16x16x32_bf16 a[100:103], a[40:43], a[88:91], a[100:103]
    buffer_load_dwordx4 v11, s[20:23], s72 offen offset:1024 lds
    ds_read_b64_tr_b16 a[0:1], v15 offset:0
    ds_read_b64_tr_b16 a[2:3], v15 offset:1024
    ds_read_b64_tr_b16 a[44:45], v25 offset:36864
    ds_read_b64_tr_b16 a[46:47], v25 offset:37632
    v_mfma_f32_16x16x32_bf16 v[184:187], a[16:19], a[72:75], v[184:187]
    v_mfma_f32_16x16x32_bf16 v[188:191], a[16:19], a[76:79], v[188:191]
    ds_read_b128 a[60:63], v250 offset:18432
    v_mfma_f32_16x16x32_bf16 v[192:195], a[16:19], a[80:83], v[192:195]
    v_mfma_f32_16x16x32_bf16 v[196:199], a[16:19], a[84:87], v[196:199]
    buffer_load_dwordx4 v12, s[20:23], s72 offen offset:2048 lds
    ds_read_b64_tr_b16 a[4:5], v16 offset:0
    ds_read_b64_tr_b16 a[6:7], v16 offset:1024
    v_mfma_f32_16x16x32_bf16 v[200:203], a[20:23], a[72:75], v[200:203]
    v_mfma_f32_16x16x32_bf16 v[204:207], a[20:23], a[76:79], v[204:207]
    ds_read_b128 a[64:67], v250 offset:20480
    v_mfma_f32_16x16x32_bf16 v[208:211], a[20:23], a[80:83], v[208:211]
    v_mfma_f32_16x16x32_bf16 v[212:215], a[20:23], a[84:87], v[212:215]
    s_waitcnt lgkmcnt(4)
    v_mfma_f32_16x16x32_bf16 a[104:107], a[44:47], a[88:91], a[104:107]
    buffer_load_dwordx4 v13, s[20:23], s72 offen offset:3072 lds
    ds_read_b64_tr_b16 a[8:9], v17 offset:0
    ds_read_b64_tr_b16 a[10:11], v17 offset:1024
    ds_read_b64_tr_b16 a[48:49], v26 offset:36864
    ds_read_b64_tr_b16 a[50:51], v26 offset:37632
    v_mfma_f32_16x16x32_bf16 v[216:219], a[24:27], a[72:75], v[216:219]
    v_mfma_f32_16x16x32_bf16 v[220:223], a[24:27], a[76:79], v[220:223]
    ds_read_b128 a[68:71], v252 offset:18432
    v_mfma_f32_16x16x32_bf16 v[224:227], a[24:27], a[80:83], v[224:227]
    v_mfma_f32_16x16x32_bf16 v[228:231], a[24:27], a[84:87], v[228:231]
    s_add_u32 m0, s50, 0
    s_mov_b64 exec, s[46:47]
    buffer_load_dwordx4 v14, s[20:23], s72 offen lds
    s_mov_b64 exec, -1
    ds_read_b64_tr_b16 a[12:13], v18 offset:0
    ds_read_b64_tr_b16 a[14:15], v18 offset:1024
    v_mfma_f32_16x16x32_bf16 v[232:235], a[28:31], a[72:75], v[232:235]
    v_mfma_f32_16x16x32_bf16 v[236:239], a[28:31], a[76:79], v[236:239]
    v_mfma_f32_16x16x32_bf16 v[240:243], a[28:31], a[80:83], v[240:243]
    v_mfma_f32_16x16x32_bf16 v[244:247], a[28:31], a[84:87], v[244:247]
    s_waitcnt lgkmcnt(3)
    v_mfma_f32_16x16x32_bf16 a[108:111], a[48:51], a[88:91], a[108:111]
    s_waitcnt vmcnt(15)
    s_barrier
    ds_read_b64_tr_b16 a[16:17], v19 offset:0
    ds_read_b64_tr_b16 a[18:19], v19 offset:768
    ds_read_b64_tr_b16 a[32:33], v22 offset:0
    ds_read_b64_tr_b16 a[34:35], v22 offset:1024
    s_waitcnt lgkmcnt(6)
    v_mfma_f32_16x16x32_bf16 v[88:91], a[0:3], a[52:55], v[88:91]
    v_mfma_f32_16x16x32_bf16 v[92:95], a[0:3], a[56:59], v[92:95]
    s_cmp_eq_u32 s98, 0
    s_cbranch_scc1 k1_hs1
    v_mov_b32 v58, v54
    v_mov_b32 v59, v55
    v_mov_b32 v60, v56
    v_mov_b32 v61, v57
k1_hs1:
    s_mov_b64 exec, s[92:93]
    buffer_store_dwordx4 v[58:61], v53, s[64:67], 0 offen sc1
    s_mov_b64 exec, -1
    v_mfma_f32_16x16x32_bf16 v[96:99], a[0:3], a[60:63], v[96:99]
    v_mfma_f32_16x16x32_bf16 v[100:103], a[0:3], a[64:67], v[100:103]
    v_mfma_f32_16x16x32_bf16 a[112:115], a[52:55], a[52:55], a[112:115]
    s_add_u32 m0, s52, 36864
    s_mul_i32 s49, s10, 98304
    s_mul_i32 s48, s10, 122880
    s_add_u32 s10, s10, 1
    s_cmp_eq_u32 s10, 20
    s_cselect_b32 s10, 0, s10
    buffer_load_dwordx4 v7, s[28:31], s49 offen offset:0 lds
    ds_read_b64_tr_b16 a[20:21], v20 offset:0
    ds_read_b64_tr_b16 a[22:23], v20 offset:768
    v_mfma_f32_16x16x32_bf16 v[104:107], a[4:7], a[52:55], v[104:107]
    v_mfma_f32_16x16x32_bf16 v[108:111], a[4:7], a[56:59], v[108:111]
    v_mfma_f32_16x16x32_bf16 v[112:115], a[4:7], a[60:63], v[112:115]
    v_mfma_f32_16x16x32_bf16 v[116:119], a[4:7], a[64:67], v[116:119]
    s_waitcnt lgkmcnt(2)
    v_mfma_f32_16x16x32_bf16 a[92:95], a[32:35], a[68:71], a[92:95]
    buffer_load_dwordx4 v8, s[28:31], s49 offen offset:1024 lds
    ds_read_b64_tr_b16 a[24:25], v21 offset:0
    ds_read_b64_tr_b16 a[26:27], v21 offset:768
    ds_read_b64_tr_b16 a[36:37], v23 offset:0
    ds_read_b64_tr_b16 a[38:39], v23 offset:1024
    v_mfma_f32_16x16x32_bf16 v[120:123], a[8:11], a[52:55], v[120:123]
    v_mfma_f32_16x16x32_bf16 v[124:127], a[8:11], a[56:59], v[124:127]
    v_mfma_f32_16x16x32_bf16 v[128:131], a[8:11], a[60:63], v[128:131]
    v_mfma_f32_16x16x32_bf16 v[132:135], a[8:11], a[64:67], v[132:135]
    v_mfma_f32_16x16x32_bf16 a[116:119], a[56:59], a[56:59], a[116:119]
    buffer_load_dwordx4 v9, s[28:31], s49 offen offset:2048 lds
    ds_read_b64_tr_b16 a[28:29], v19 offset:6144
    ds_read_b64_tr_b16 a[30:31], v19 offset:6912
    v_mfma_f32_16x16x32_bf16 v[136:139], a[12:15], a[52:55], v[136:139]
    v_mfma_f32_16x16x32_bf16 v[140:143], a[12:15], a[56:59], v[140:143]
    v_mfma_f32_16x16x32_bf16 v[144:147], a[12:15], a[60:63], v[144:147]
    v_mfma_f32_16x16x32_bf16 v[148:151], a[12:15], a[64:67], v[148:151]
    s_waitcnt lgkmcnt(2)
    v_mfma_f32_16x16x32_bf16 a[96:99], a[36:39], a[68:71], a[96:99]
    s_add_u32 m0, s51, 24576
    s_mov_b64 exec, s[44:45]
    buffer_load_dwordx4 v5, s[24:27], s48 offen offset:0 lds
    buffer_load_dwordx4 v6, s[24:27], s48 offen offset:1024 lds
    s_mov_b64 exec, -1
    ds_read_b64_tr_b16 a[0:1], v20 offset:6144
    ds_read_b64_tr_b16 a[2:3], v20 offset:6912
    ds_read_b64_tr_b16 a[40:41], v24 offset:0
    ds_read_b64_tr_b16 a[42:43], v24 offset:768
    v_mfma_f32_16x16x32_bf16 v[152:155], a[16:19], a[52:55], v[152:155]
    v_mfma_f32_16x16x32_bf16 v[156:159], a[16:19], a[56:59], v[156:159]
    ds_read_b128 a[72:75], v249 offset:18432
    v_mfma_f32_16x16x32_bf16 v[160:163], a[16:19], a[60:63], v[160:163]
    v_mfma_f32_16x16x32_bf16 v[164:167], a[16:19], a[64:67], v[164:167]
    v_mfma_f32_16x16x32_bf16 a[120:123], a[68:71], a[68:71], a[120:123]
    ds_read_b64_tr_b16 a[4:5], v21 offset:6144
    ds_read_b64_tr_b16 a[6:7], v21 offset:6912
    v_mfma_f32_16x16x32_bf16 v[168:171], a[20:23], a[52:55], v[168:171]
    v_mfma_f32_16x16x32_bf16 v[172:175], a[20:23], a[56:59], v[172:175]
    ds_read_b128 a[76:79], v249 offset:20480
    v_mfma_f32_16x16x32_bf16 v[176:179], a[20:23], a[60:63], v[176:179]
    v_mfma_f32_16x16x32_bf16 v[180:183], a[20:23], a[64:67], v[180:183]
    s_waitcnt lgkmcnt(4)
    v_mfma_f32_16x16x32_bf16 a[100:103], a[40:43], a[68:71], a[100:103]
    ds_read_b64_tr_b16 a[8:9], v15 offset:8192
    ds_read_b64_tr_b16 a[10:11], v15 offset:9216
    ds_read_b64_tr_b16 a[44:45], v25 offset:0
    ds_read_b64_tr_b16 a[46:47], v25 offset:768
    v_mfma_f32_16x16x32_bf16 v[184:187], a[24:27], a[52:55], v[184:187]
    v_mfma_f32_16x16x32_bf16 v[188:191], a[24:27], a[56:59], v[188:191]
    ds_read_b128 a[80:83], v251 offset:18432
    v_mfma_f32_16x16x32_bf16 v[192:195], a[24:27], a[60:63], v[192:195]
    v_mfma_f32_16x16x32_bf16 v[196:199], a[24:27], a[64:67], v[196:199]
    ds_read_b64_tr_b16 a[12:13], v16 offset:8192
    ds_read_b64_tr_b16 a[14:15], v16 offset:9216
    v_mfma_f32_16x16x32_bf16 v[200:203], a[28:31], a[52:55], v[200:203]
    v_mfma_f32_16x16x32_bf16 v[204:207], a[28:31], a[56:59], v[204:207]
    ds_read_b128 a[84:87], v251 offset:20480
    v_mfma_f32_16x16x32_bf16 v[208:211], a[28:31], a[60:63], v[208:211]
    v_mfma_f32_16x16x32_bf16 v[212:215], a[28:31], a[64:67], v[212:215]
    s_waitcnt lgkmcnt(4)
    v_mfma_f32_16x16x32_bf16 a[104:107], a[44:47], a[68:71], a[104:107]
    ds_read_b64_tr_b16 a[16:17], v17 offset:8192
    ds_read_b64_tr_b16 a[18:19], v17 offset:9216
    ds_read_b64_tr_b16 a[48:49], v26 offset:0
    ds_read_b64_tr_b16 a[50:51], v26 offset:768
    v_mfma_f32_16x16x32_bf16 v[216:219], a[0:3], a[52:55], v[216:219]
    v_mfma_f32_16x16x32_bf16 v[220:223], a[0:3], a[56:59], v[220:223]
    ds_read_b128 a[88:91], v253 offset:18432
    v_mfma_f32_16x16x32_bf16 v[224:227], a[0:3], a[60:63], v[224:227]
    v_mfma_f32_16x16x32_bf16 v[228:231], a[0:3], a[64:67], v[228:231]
    ds_read_b64_tr_b16 a[20:21], v18 offset:8192
    ds_read_b64_tr_b16 a[22:23], v18 offset:9216
    v_mfma_f32_16x16x32_bf16 v[232:235], a[4:7], a[52:55], v[232:235]
    v_mfma_f32_16x16x32_bf16 v[236:239], a[4:7], a[56:59], v[236:239]
    v_mfma_f32_16x16x32_bf16 v[240:243], a[4:7], a[60:63], v[240:243]
    v_mfma_f32_16x16x32_bf16 v[244:247], a[4:7], a[64:67], v[244:247]
    s_waitcnt lgkmcnt(3)
    v_mfma_f32_16x16x32_bf16 a[108:111], a[48:51], a[68:71], a[108:111]
    s_waitcnt vmcnt(12)
    s_barrier
    ds_read_b64_tr_b16 a[24:25], v19 offset:12288
    ds_read_b64_tr_b16 a[26:27], v19 offset:13056
    ds_read_b64_tr_b16 a[32:33], v22 offset:8192
    ds_read_b64_tr_b16 a[34:35], v22 offset:9216
    s_waitcnt lgkmcnt(6)
    v_mfma_f32_16x16x32_bf16 v[88:91], a[8:11], a[72:75], v[88:91]
    v_mfma_f32_16x16x32_bf16 v[92:95], a[8:11], a[76:79], v[92:95]
    s_mov_b64 exec, s[92:93]
    buffer_load_dwordx4 v[54:57], v52, s[64:67], 0 offen sc1
    s_mov_b64 exec, -1
    v_mfma_f32_16x16x32_bf16 v[96:99], a[8:11], a[80:83], v[96:99]
    v_mfma_f32_16x16x32_bf16 v[100:103], a[8:11], a[84:87], v[100:103]
    v_mfma_f32_16x16x32_bf16 a[112:115], a[72:75], a[72:75], a[112:115]
    s_add_u32 m0, s52, 0
    s_mul_i32 s49, s10, 98304
    s_mul_i32 s48, s10, 122880
    s_add_u32 s10, s10, 1
    s_cmp_eq_u32 s10, 20
    s_cselect_b32 s10, 0, s10
    buffer_load_dwordx4 v7, s[28:31], s49 offen offset:0 lds
    ds_read_b64_tr_b16 a[28:29], v20 offset:12288
    ds_read_b64_tr_b16 a[30:31], v20 offset:13056
    v_mfma_f32_16x16x32_bf16 v[104:107], a[12:15], a[72:75], v[104:107]
    v_mfma_f32_16x16x32_bf16 v[108:111], a[12:15], a[76:79], v[108:111]
    v_mfma_f32_16x16x32_bf16 v[112:115], a[12:15], a[80:83], v[112:115]
    v_mfma_f32_16x16x32_bf16 v[116:119], a[12:15], a[84:87], v[116:119]
    s_waitcnt lgkmcnt(2)
    v_mfma_f32_16x16x32_bf16 a[92:95], a[32:35], a[88:91], a[92:95]
    buffer_load_dwordx4 v8, s[28:31], s49 offen offset:1024 lds
    ds_read_b64_tr_b16 a[0:1], v21 offset:12288
    ds_read_b64_tr_b16 a[2:3], v21 offset:13056
    ds_read_b64_tr_b16 a[36:37], v23 offset:8192
    ds_read_b64_tr_b16 a[38:39], v23 offset:9216
    v_mfma_f32_16x16x32_bf16 v[120:123], a[16:19], a[72:75], v[120:123]
    v_mfma_f32_16x16x32_bf16 v[124:127], a[16:19], a[76:79], v[124:127]
    v_mfma_f32_16x16x32_bf16 v[128:131], a[16:19], a[80:83], v[128:131]
    v_mfma_f32_16x16x32_bf16 v[132:135], a[16:19], a[84:87], v[132:135]
    v_mfma_f32_16x16x32_bf16 a[116:119], a[76:79], a[76:79], a[116:119]
    buffer_load_dwordx4 v9, s[28:31], s49 offen offset:2048 lds
    ds_read_b64_tr_b16 a[4:5], v19 offset:18432
    ds_read_b64_tr_b16 a[6:7], v19 offset:19200
    v_mfma_f32_16x16x32_bf16 v[136:139], a[20:23], a[72:75], v[136:139]
    v_mfma_f32_16x16x32_bf16 v[140:143], a[20:23], a[76:79], v[140:143]
    v_mfma_f32_16x16x32_bf16 v[144:147], a[20:23], a[80:83], v[144:147]
    v_mfma_f32_16x16x32_bf16 v[148:151], a[20:23], a[84:87], v[148:151]
    s_waitcnt lgkmcnt(2)
    v_mfma_f32_16x16x32_bf16 a[96:99], a[36:39], a[88:91], a[96:99]
    s_add_u32 m0, s51, 0
    s_mov_b64 exec, s[44:45]
    buffer_load_dwordx4 v5, s[24:27], s48 offen offset:0 lds
    buffer_load_dwordx4 v6, s[24:27], s48 offen offset:1024 lds
    s_mov_b64 exec, -1
    ds_read_b64_tr_b16 a[8:9], v20 offset:18432
    ds_read_b64_tr_b16 a[10:11], v20 offset:19200
    ds_read_b64_tr_b16 a[40:41], v24 offset:12288
    ds_read_b64_tr_b16 a[42:43], v24 offset:13056
    v_mfma_f32_16x16x32_bf16 v[152:155], a[24:27], a[72:75], v[152:155]
    v_mfma_f32_16x16x32_bf16 v[156:159], a[24:27], a[76:79], v[156:159]
    ds_read_b128 a[52:55], v248 offset:36864
    v_mfma_f32_16x16x32_bf16 v[160:163], a[24:27], a[80:83], v[160:163]
    v_mfma_f32_16x16x32_bf16 v[164:167], a[24:27], a[84:87], v[164:167]
    v_mfma_f32_16x16x32_bf16 a[120:123], a[88:91], a[88:91], a[120:123]
    s_add_u32 m0, s53, 18432
    s_mov_b32 s72, s11
    s_add_u32 s11, s11, 128
    s_cmp_eq_u32 s11, 1280
    s_cselect_b32 s11, 0, s11
    buffer_load_dwordx4 v10, s[20:23], s72 offen offset:0 lds
    ds_read_b64_tr_b16 a[12:13], v21 offset:18432
    ds_read_b64_tr_b16 a[14:15], v21 offset:19200
    v_mfma_f32_16x16x32_bf16 v[168:171], a[28:31], a[72:75], v[168:171]
    v_mfma_f32_16x16x32_bf16 v[172:175], a[28:31], a[76:79], v[172:175]
    ds_read_b128 a[56:59], v248 offset:38912
    v_mfma_f32_16x16x32_bf16 v[176:179], a[28:31], a[80:83], v[176:179]
    v_mfma_f32_16x16x32_bf16 v[180:183], a[28:31], a[84:87], v[180:183]
    s_waitcnt lgkmcnt(4)
    v_mfma_f32_16x16x32_bf16 a[100:103], a[40:43], a[88:91], a[100:103]
    buffer_load_dwordx4 v11, s[20:23], s72 offen offset:1024 lds
    ds_read_b64_tr_b16 a[16:17], v15 offset:16384
    ds_read_b64_tr_b16 a[18:19], v15 offset:17408
    ds_read_b64_tr_b16 a[44:45], v25 offset:12288
    ds_read_b64_tr_b16 a[46:47], v25 offset:13056
    v_mfma_f32_16x16x32_bf16 v[184:187], a[0:3], a[72:75], v[184:187]
    v_mfma_f32_16x16x32_bf16 v[188:191], a[0:3], a[76:79], v[188:191]
    ds_read_b128 a[60:63], v250 offset:36864
    v_mfma_f32_16x16x32_bf16 v[192:195], a[0:3], a[80:83], v[192:195]
    v_mfma_f32_16x16x32_bf16 v[196:199], a[0:3], a[84:87], v[196:199]
    buffer_load_dwordx4 v12, s[20:23], s72 offen offset:2048 lds
    ds_read_b64_tr_b16 a[20:21], v16 offset:16384
    ds_read_b64_tr_b16 a[22:23], v16 offset:17408
    v_mfma_f32_16x16x32_bf16 v[200:203], a[4:7], a[72:75], v[200:203]
    v_mfma_f32_16x16x32_bf16 v[204:207], a[4:7], a[76:79], v[204:207]
    ds_read_b128 a[64:67], v250 offset:38912
    v_mfma_f32_16x16x32_bf16 v[208:211], a[4:7], a[80:83], v[208:211]
    v_mfma_f32_16x16x32_bf16 v[212:215], a[4:7], a[84:87], v[212:215]
    s_waitcnt lgkmcnt(4)
    v_mfma_f32_16x16x32_bf16 a[104:107], a[44:47], a[88:91], a[104:107]
    buffer_load_dwordx4 v13, s[20:23], s72 offen offset:3072 lds
    ds_read_b64_tr_b16 a[24:25], v17 offset:16384
    ds_read_b64_tr_b16 a[26:27], v17 offset:17408
    ds_read_b64_tr_b16 a[48:49], v26 offset:12288
    ds_read_b64_tr_b16 a[50:51], v26 offset:13056
    v_mfma_f32_16x16x32_bf16 v[216:219], a[8:11], a[72:75], v[216:219]
    v_mfma_f32_16x16x32_bf16 v[220:223], a[8:11], a[76:79], v[220:223]
    ds_read_b128 a[68:71], v252 offset:36864
    v_mfma_f32_16x16x32_bf16 v[224:227], a[8:11], a[80:83], v[224:227]
    v_mfma_f32_16x16x32_bf16 v[228:231], a[8:11], a[84:87], v[228:231]
    s_add_u32 m0, s50, 18432
    s_mov_b64 exec, s[46:47]
    buffer_load_dwordx4 v14, s[20:23], s72 offen lds
    s_mov_b64 exec, -1
    ds_read_b64_tr_b16 a[28:29], v18 offset:16384
    ds_read_b64_tr_b16 a[30:31], v18 offset:17408
    v_mfma_f32_16x16x32_bf16 v[232:235], a[12:15], a[72:75], v[232:235]
    v_mfma_f32_16x16x32_bf16 v[236:239], a[12:15], a[76:79], v[236:239]
    v_mfma_f32_16x16x32_bf16 v[240:243], a[12:15], a[80:83], v[240:243]
    v_mfma_f32_16x16x32_bf16 v[244:247], a[12:15], a[84:87], v[244:247]
    s_waitcnt lgkmcnt(3)
    v_mfma_f32_16x16x32_bf16 a[108:111], a[48:51], a[88:91], a[108:111]
    s_waitcnt vmcnt(11)
    s_barrier
    ds_read_b64_tr_b16 a[0:1], v19 offset:24576
    ds_read_b64_tr_b16 a[2:3], v19 offset:25344
    ds_read_b64_tr_b16 a[32:33], v22 offset:16384
    ds_read_b64_tr_b16 a[34:35], v22 offset:17408
    s_waitcnt lgkmcnt(6)
    v_mfma_f32_16x16x32_bf16 v[88:91], a[16:19], a[52:55], v[88:91]
    v_mfma_f32_16x16x32_bf16 v[92:95], a[16:19], a[56:59], v[92:95]
    v_mfma_f32_16x16x32_bf16 v[96:99], a[16:19], a[60:63], v[96:99]
    v_mfma_f32_16x16x32_bf16 v[100:103], a[16:19], a[64:67], v[100:103]
    v_mfma_f32_16x16x32_bf16 a[112:115], a[52:55], a[52:55], a[112:115]
    s_add_u32 m0, s52, 12288
    s_mul_i32 s49, s10, 98304
    s_mul_i32 s48, s10, 122880
    s_add_u32 s10, s10, 1
    s_cmp_eq_u32 s10, 20
    s_cselect_b32 s10, 0, s10
    buffer_load_dwordx4 v7, s[28:31], s49 offen offset:0 lds
    ds_read_b64_tr_b16 a[4:5], v20 offset:24576
    ds_read_b64_tr_b16 a[6:7], v20 offset:25344
    v_mfma_f32_16x16x32_bf16 v[104:107], a[20:23], a[52:55], v[104:107]
    v_mfma_f32_16x16x32_bf16 v[108:111], a[20:23], a[56:59], v[108:111]
    v_mfma_f32_16x16x32_bf16 v[112:115], a[20:23], a[60:63], v[112:115]
    v_mfma_f32_16x16x32_bf16 v[116:119], a[20:23], a[64:67], v[116:119]
    s_waitcnt lgkmcnt(2)
    v_mfma_f32_16x16x32_bf16 a[92:95], a[32:35], a[68:71], a[92:95]
    buffer_load_dwordx4 v8, s[28:31], s49 offen offset:1024 lds
    ds_read_b64_tr_b16 a[8:9], v21 offset:24576
    ds_read_b64_tr_b16 a[10:11], v21 offset:25344
    ds_read_b64_tr_b16 a[36:37], v23 offset:16384
    ds_read_b64_tr_b16 a[38:39], v23 offset:17408
    v_mfma_f32_16x16x32_bf16 v[120:123], a[24:27], a[52:55], v[120:123]
    v_mfma_f32_16x16x32_bf16 v[124:127], a[24:27], a[56:59], v[124:127]
    v_mfma_f32_16x16x32_bf16 v[128:131], a[24:27], a[60:63], v[128:131]
    v_mfma_f32_16x16x32_bf16 v[132:135], a[24:27], a[64:67], v[132:135]
    v_mfma_f32_16x16x32_bf16 a[116:119], a[56:59], a[56:59], a[116:119]
    buffer_load_dwordx4 v9, s[28:31], s49 offen offset:2048 lds
    ds_read_b64_tr_b16 a[12:13], v19 offset:30720
    ds_read_b64_tr_b16 a[14:15], v19 offset:31488
    v_mfma_f32_16x16x32_bf16 v[136:139], a[28:31], a[52:55], v[136:139]
    v_mfma_f32_16x16x32_bf16 v[140:143], a[28:31], a[56:59], v[140:143]
    v_mfma_f32_16x16x32_bf16 v[144:147], a[28:31], a[60:63], v[144:147]
    v_mfma_f32_16x16x32_bf16 v[148:151], a[28:31], a[64:67], v[148:151]
    s_waitcnt lgkmcnt(2)
    v_mfma_f32_16x16x32_bf16 a[96:99], a[36:39], a[68:71], a[96:99]
    s_add_u32 m0, s51, 8192
    s_mov_b64 exec, s[44:45]
    buffer_load_dwordx4 v5, s[24:27], s48 offen offset:0 lds
    buffer_load_dwordx4 v6, s[24:27], s48 offen offset:1024 lds
    s_mov_b64 exec, -1
    ds_read_b64_tr_b16 a[16:17], v20 offset:30720
    ds_read_b64_tr_b16 a[18:19], v20 offset:31488
    ds_read_b64_tr_b16 a[40:41], v24 offset:24576
    ds_read_b64_tr_b16 a[42:43], v24 offset:25344
    v_mfma_f32_16x16x32_bf16 v[152:155], a[0:3], a[52:55], v[152:155]
    v_mfma_f32_16x16x32_bf16 v[156:159], a[0:3], a[56:59], v[156:159]
    ds_read_b128 a[72:75], v249 offset:36864
    v_mfma_f32_16x16x32_bf16 v[160:163], a[0:3], a[60:63], v[160:163]
    v_mfma_f32_16x16x32_bf16 v[164:167], a[0:3], a[64:67], v[164:167]
    v_mfma_f32_16x16x32_bf16 a[120:123], a[68:71], a[68:71], a[120:123]
    ds_read_b64_tr_b16 a[20:21], v21 offset:30720
    ds_read_b64_tr_b16 a[22:23], v21 offset:31488
    v_mfma_f32_16x16x32_bf16 v[168:171], a[4:7], a[52:55], v[168:171]
    v_mfma_f32_16x16x32_bf16 v[172:175], a[4:7], a[56:59], v[172:175]
    ds_read_b128 a[76:79], v249 offset:38912
    v_mfma_f32_16x16x32_bf16 v[176:179], a[4:7], a[60:63], v[176:179]
    v_mfma_f32_16x16x32_bf16 v[180:183], a[4:7], a[64:67], v[180:183]
    s_waitcnt lgkmcnt(4)
    v_mfma_f32_16x16x32_bf16 a[100:103], a[40:43], a[68:71], a[100:103]
    ds_read_b64_tr_b16 a[24:25], v15 offset:24576
    ds_read_b64_tr_b16 a[26:27], v15 offset:25600
    ds_read_b64_tr_b16 a[44:45], v25 offset:24576
    ds_read_b64_tr_b16 a[46:47], v25 offset:25344
    v_mfma_f32_16x16x32_bf16 v[184:187], a[8:11], a[52:55], v[184:187]
    v_mfma_f32_16x16x32_bf16 v[188:191], a[8:11], a[56:59], v[188:191]
    ds_read_b128 a[80:83], v251 offset:36864
    v_mfma_f32_16x16x32_bf16 v[192:195], a[8:11], a[60:63], v[192:195]
    v_mfma_f32_16x16x32_bf16 v[196:199], a[8:11], a[64:67], v[196:199]
    ds_read_b64_tr_b16 a[28:29], v16 offset:24576
    ds_read_b64_tr_b16 a[30:31], v16 offset:25600
    v_mfma_f32_16x16x32_bf16 v[200:203], a[12:15], a[52:55], v[200:203]
    v_mfma_f32_16x16x32_bf16 v[204:207], a[12:15], a[56:59], v[204:207]
    ds_read_b128 a[84:87], v251 offset:38912
    v_mfma_f32_16x16x32_bf16 v[208:211], a[12:15], a[60:63], v[208:211]
    v_mfma_f32_16x16x32_bf16 v[212:215], a[12:15], a[64:67], v[212:215]
    s_waitcnt lgkmcnt(4)
    v_mfma_f32_16x16x32_bf16 a[104:107], a[44:47], a[68:71], a[104:107]
    ds_read_b64_tr_b16 a[0:1], v17 offset:24576
    ds_read_b64_tr_b16 a[2:3], v17 offset:25600
    ds_read_b64_tr_b16 a[48:49], v26 offset:24576
    ds_read_b64_tr_b16 a[50:51], v26 offset:25344
    v_mfma_f32_16x16x32_bf16 v[216:219], a[16:19], a[52:55], v[216:219]
    v_mfma_f32_16x16x32_bf16 v[220:223], a[16:19], a[56:59], v[220:223]
    ds_read_b128 a[88:91], v253 offset:36864
    v_mfma_f32_16x16x32_bf16 v[224:227], a[16:19], a[60:63], v[224:227]
    v_mfma_f32_16x16x32_bf16 v[228:231], a[16:19], a[64:67], v[228:231]
    ds_read_b64_tr_b16 a[4:5], v18 offset:24576
    ds_read_b64_tr_b16 a[6:7], v18 offset:25600
    v_mfma_f32_16x16x32_bf16 v[232:235], a[20:23], a[52:55], v[232:235]
    v_mfma_f32_16x16x32_bf16 v[236:239], a[20:23], a[56:59], v[236:239]
    v_mfma_f32_16x16x32_bf16 v[240:243], a[20:23], a[60:63], v[240:243]
    v_mfma_f32_16x16x32_bf16 v[244:247], a[20:23], a[64:67], v[244:247]
    s_waitcnt lgkmcnt(3)
    v_mfma_f32_16x16x32_bf16 a[108:111], a[48:51], a[68:71], a[108:111]
    s_waitcnt vmcnt(10)
    s_barrier
    ds_read_b64_tr_b16 a[8:9], v19 offset:36864
    ds_read_b64_tr_b16 a[10:11], v19 offset:37632
    ds_read_b64_tr_b16 a[32:33], v22 offset:24576
    ds_read_b64_tr_b16 a[34:35], v22 offset:25600
    s_waitcnt lgkmcnt(6)
    v_mfma_f32_16x16x32_bf16 v[88:91], a[24:27], a[72:75], v[88:91]
    v_mfma_f32_16x16x32_bf16 v[92:95], a[24:27], a[76:79], v[92:95]
    s_cmp_eq_u32 s98, 0
    s_cbranch_scc1 k1_hs2
    v_mov_b32 v58, v54
    v_mov_b32 v59, v55
    v_mov_b32 v60, v56
    v_mov_b32 v61, v57
k1_hs2:
    s_mov_b64 exec, s[92:93]
    buffer_store_dwordx4 v[58:61], v53, s[64:67], 0 offen sc1
    s_mov_b64 exec, -1
    v_mfma_f32_16x16x32_bf16 v[96:99], a[24:27], a[80:83], v[96:99]
    v_mfma_f32_16x16x32_bf16 v[100:103], a[24:27], a[84:87], v[100:103]
    v_mfma_f32_16x16x32_bf16 a[112:115], a[72:75], a[72:75], a[112:115]
    s_add_u32 m0, s52, 24576
    s_mul_i32 s49, s10, 98304
    s_mul_i32 s48, s10, 122880
    s_add_u32 s10, s10, 1
    s_cmp_eq_u32 s10, 20
    s_cselect_b32 s10, 0, s10
    buffer_load_dwordx4 v7, s[28:31], s49 offen offset:0 lds
    ds_read_b64_tr_b16 a[12:13], v20 offset:36864
    ds_read_b64_tr_b16 a[14:15], v20 offset:37632
    v_mfma_f32_16x16x32_bf16 v[104:107], a[28:31], a[72:75], v[104:107]
    v_mfma_f32_16x16x32_bf16 v[108:111], a[28:31], a[76:79], v[108:111]
    v_mfma_f32_16x16x32_bf16 v[112:115], a[28:31], a[80:83], v[112:115]
    v_mfma_f32_16x16x32_bf16 v[116:119], a[28:31], a[84:87], v[116:119]
    s_waitcnt lgkmcnt(2)
    v_mfma_f32_16x16x32_bf16 a[92:95], a[32:35], a[88:91], a[92:95]
    buffer_load_dwordx4 v8, s[28:31], s49 offen offset:1024 lds
    ds_read_b64_tr_b16 a[16:17], v21 offset:36864
    ds_read_b64_tr_b16 a[18:19], v21 offset:37632
    ds_read_b64_tr_b16 a[36:37], v23 offset:24576
    ds_read_b64_tr_b16 a[38:39], v23 offset:25600
    v_mfma_f32_16x16x32_bf16 v[120:123], a[0:3], a[72:75], v[120:123]
    v_mfma_f32_16x16x32_bf16 v[124:127], a[0:3], a[76:79], v[124:127]
    v_mfma_f32_16x16x32_bf16 v[128:131], a[0:3], a[80:83], v[128:131]
    v_mfma_f32_16x16x32_bf16 v[132:135], a[0:3], a[84:87], v[132:135]
    v_mfma_f32_16x16x32_bf16 a[116:119], a[76:79], a[76:79], a[116:119]
    buffer_load_dwordx4 v9, s[28:31], s49 offen offset:2048 lds
    ds_read_b64_tr_b16 a[20:21], v19 offset:43008
    ds_read_b64_tr_b16 a[22:23], v19 offset:43776
    v_mfma_f32_16x16x32_bf16 v[136:139], a[4:7], a[72:75], v[136:139]
    v_mfma_f32_16x16x32_bf16 v[140:143], a[4:7], a[76:79], v[140:143]
    v_mfma_f32_16x16x32_bf16 v[144:147], a[4:7], a[80:83], v[144:147]
    v_mfma_f32_16x16x32_bf16 v[148:151], a[4:7], a[84:87], v[148:151]
    s_waitcnt lgkmcnt(2)
    v_mfma_f32_16x16x32_bf16 a[96:99], a[36:39], a[88:91], a[96:99]
    s_add_u32 m0, s51, 16384
    s_mov_b64 exec, s[44:45]
    buffer_load_dwordx4 v5, s[24:27], s48 offen offset:0 lds
    buffer_load_dwordx4 v6, s[24:27], s48 offen offset:1024 lds
    s_mov_b64 exec, -1
    ds_read_b64_tr_b16 a[24:25], v20 offset:43008
    ds_read_b64_tr_b16 a[26:27], v20 offset:43776
    ds_read_b64_tr_b16 a[40:41], v24 offset:36864
    ds_read_b64_tr_b16 a[42:43], v24 offset:37632
    v_mfma_f32_16x16x32_bf16 v[152:155], a[8:11], a[72:75], v[152:155]
    v_mfma_f32_16x16x32_bf16 v[156:159], a[8:11], a[76:79], v[156:159]
    ds_read_b128 a[52:55], v248 offset:0
    v_mfma_f32_16x16x32_bf16 v[160:163], a[8:11], a[80:83], v[160:163]
    v_mfma_f32_16x16x32_bf16 v[164:167], a[8:11], a[84:87], v[164:167]
    v_mfma_f32_16x16x32_bf16 a[120:123], a[88:91], a[88:91], a[120:123]
    s_add_u32 m0, s53, 36864
    s_mov_b32 s72, s11
    s_add_u32 s11, s11, 128
    s_cmp_eq_u32 s11, 1280
    s_cselect_b32 s11, 0, s11
    buffer_load_dwordx4 v10, s[20:23], s72 offen offset:0 lds
    ds_read_b64_tr_b16 a[28:29], v21 offset:43008
    ds_read_b64_tr_b16 a[30:31], v21 offset:43776
    v_mfma_f32_16x16x32_bf16 v[168:171], a[12:15], a[72:75], v[168:171]
    v_mfma_f32_16x16x32_bf16 v[172:175], a[12:15], a[76:79], v[172:175]
    ds_read_b128 a[56:59], v248 offset:2048
    v_mfma_f32_16x16x32_bf16 v[176:179], a[12:15], a[80:83], v[176:179]
    v_mfma_f32_16x16x32_bf16 v[180:183], a[12:15], a[84:87], v[180:183]
    s_waitcnt lgkmcnt(4)
    v_mfma_f32_16x16x32_bf16 a[100:103], a[40:43], a[88:91], a[100:103]
    buffer_load_dwordx4 v11, s[20:23], s72 offen offset:1024 lds
    ds_read_b64_tr_b16 a[0:1], v15 offset:0
    ds_read_b64_tr_b16 a[2:3], v15 offset:1024
    ds_read_b64_tr_b16 a[44:45], v25 offset:36864
    ds_read_b64_tr_b16 a[46:47], v25 offset:37632
    v_mfma_f32_16x16x32_bf16 v[184:187], a[16:19], a[72:75], v[184:187]
    v_mfma_f32_16x16x32_bf16 v[188:191], a[16:19], a[76:79], v[188:191]
    ds_read_b128 a[60:63], v250 offset:0
    v_mfma_f32_16x16x32_bf16 v[192:195], a[16:19], a[80:83], v[192:195]
    v_mfma_f32_16x16x32_bf16 v[196:199], a[16:19], a[84:87], v[196:199]
    buffer_load_dwordx4 v12, s[20:23], s72 offen offset:2048 lds
    ds_read_b64_tr_b16 a[4:5], v16 offset:0
    ds_read_b64_tr_b16 a[6:7], v16 offset:1024
    v_mfma_f32_16x16x32_bf16 v[200:203], a[20:23], a[72:75], v[200:203]
    v_mfma_f32_16x16x32_bf16 v[204:207], a[20:23], a[76:79], v[204:207]
    ds_read_b128 a[64:67], v250 offset:2048
    v_mfma_f32_16x16x32_bf16 v[208:211], a[20:23], a[80:83], v[208:211]
    v_mfma_f32_16x16x32_bf16 v[212:215], a[20:23], a[84:87], v[212:215]
    s_waitcnt lgkmcnt(4)
    v_mfma_f32_16x16x32_bf16 a[104:107], a[44:47], a[88:91], a[104:107]
    buffer_load_dwordx4 v13, s[20:23], s72 offen offset:3072 lds
    ds_read_b64_tr_b16 a[8:9], v17 offset:0
    ds_read_b64_tr_b16 a[10:11], v17 offset:1024
    ds_read_b64_tr_b16 a[48:49], v26 offset:36864
    ds_read_b64_tr_b16 a[50:51], v26 offset:37632
    v_mfma_f32_16x16x32_bf16 v[216:219], a[24:27], a[72:75], v[216:219]
    v_mfma_f32_16x16x32_bf16 v[220:223], a[24:27], a[76:79], v[220:223]
    ds_read_b128 a[68:71], v252 offset:0
    v_mfma_f32_16x16x32_bf16 v[224:227], a[24:27], a[80:83], v[224:227]
    v_mfma_f32_16x16x32_bf16 v[228:231], a[24:27], a[84:87], v[228:231]
    s_add_u32 m0, s50, 36864
    s_mov_b64 exec, s[46:47]
    buffer_load_dwordx4 v14, s[20:23], s72 offen lds
    s_mov_b64 exec, -1
    ds_read_b64_tr_b16 a[12:13], v18 offset:0
    ds_read_b64_tr_b16 a[14:15], v18 offset:1024
    v_mfma_f32_16x16x32_bf16 v[232:235], a[28:31], a[72:75], v[232:235]
    v_mfma_f32_16x16x32_bf16 v[236:239], a[28:31], a[76:79], v[236:239]
    v_mfma_f32_16x16x32_bf16 v[240:243], a[28:31], a[80:83], v[240:243]
    v_mfma_f32_16x16x32_bf16 v[244:247], a[28:31], a[84:87], v[244:247]
    s_waitcnt lgkmcnt(3)
    v_mfma_f32_16x16x32_bf16 a[108:111], a[48:51], a[88:91], a[108:111]
    s_waitcnt vmcnt(11)
    s_barrier
    ds_read_b64_tr_b16 a[16:17], v19 offset:0
    ds_read_b64_tr_b16 a[18:19], v19 offset:768
    ds_read_b64_tr_b16 a[32:33], v22 offset:0
    ds_read_b64_tr_b16 a[34:35], v22 offset:1024
    s_waitcnt lgkmcnt(6)
    v_mfma_f32_16x16x32_bf16 v[88:91], a[0:3], a[52:55], v[88:91]
    v_mfma_f32_16x16x32_bf16 v[92:95], a[0:3], a[56:59], v[92:95]
    s_mov_b64 exec, s[92:93]
    buffer_load_dwordx4 v[54:57], v52, s[64:67], 0 offen sc1
    s_mov_b64 exec, -1
    v_mfma_f32_16x16x32_bf16 v[96:99], a[0:3], a[60:63], v[96:99]
    v_mfma_f32_16x16x32_bf16 v[100:103], a[0:3], a[64:67], v[100:103]
    v_mfma_f32_16x16x32_bf16 a[112:115], a[52:55], a[52:55], a[112:115]
    s_add_u32 m0, s52, 36864
    s_mul_i32 s49, s10, 98304
    s_mul_i32 s48, s10, 122880
    s_add_u32 s10, s10, 1
    s_cmp_eq_u32 s10, 20
    s_cselect_b32 s10, 0, s10
    buffer_load_dwordx4 v7, s[28:31], s49 offen offset:0 lds
    ds_read_b64_tr_b16 a[20:21], v20 offset:0
    ds_read_b64_tr_b16 a[22:23], v20 offset:768
    v_mfma_f32_16x16x32_bf16 v[104:107], a[4:7], a[52:55], v[104:107]
    v_mfma_f32_16x16x32_bf16 v[108:111], a[4:7], a[56:59], v[108:111]
    v_mfma_f32_16x16x32_bf16 v[112:115], a[4:7], a[60:63], v[112:115]
    v_mfma_f32_16x16x32_bf16 v[116:119], a[4:7], a[64:67], v[116:119]
    s_waitcnt lgkmcnt(2)
    v_mfma_f32_16x16x32_bf16 a[92:95], a[32:35], a[68:71], a[92:95]
    buffer_load_dwordx4 v8, s[28:31], s49 offen offset:1024 lds
    ds_read_b64_tr_b16 a[24:25], v21 offset:0
    ds_read_b64_tr_b16 a[26:27], v21 offset:768
    ds_read_b64_tr_b16 a[36:37], v23 offset:0
    ds_read_b64_tr_b16 a[38:39], v23 offset:1024
    v_mfma_f32_16x16x32_bf16 v[120:123], a[8:11], a[52:55], v[120:123]
    v_mfma_f32_16x16x32_bf16 v[124:127], a[8:11], a[56:59], v[124:127]
    v_mfma_f32_16x16x32_bf16 v[128:131], a[8:11], a[60:63], v[128:131]
    v_mfma_f32_16x16x32_bf16 v[132:135], a[8:11], a[64:67], v[132:135]
    v_mfma_f32_16x16x32_bf16 a[116:119], a[56:59], a[56:59], a[116:119]
    buffer_load_dwordx4 v9, s[28:31], s49 offen offset:2048 lds
    ds_read_b64_tr_b16 a[28:29], v19 offset:6144
    ds_read_b64_tr_b16 a[30:31], v19 offset:6912
    v_mfma_f32_16x16x32_bf16 v[136:139], a[12:15], a[52:55], v[136:139]
    v_mfma_f32_16x16x32_bf16 v[140:143], a[12:15], a[56:59], v[140:143]
    v_mfma_f32_16x16x32_bf16 v[144:147], a[12:15], a[60:63], v[144:147]
    v_mfma_f32_16x16x32_bf16 v[148:151], a[12:15], a[64:67], v[148:151]
    s_waitcnt lgkmcnt(2)
    v_mfma_f32_16x16x32_bf16 a[96:99], a[36:39], a[68:71], a[96:99]
    s_add_u32 m0, s51, 24576
    s_mov_b64 exec, s[44:45]
    buffer_load_dwordx4 v5, s[24:27], s48 offen offset:0 lds
    buffer_load_dwordx4 v6, s[24:27], s48 offen offset:1024 lds
    s_mov_b64 exec, -1
    ds_read_b64_tr_b16 a[0:1], v20 offset:6144
    ds_read_b64_tr_b16 a[2:3], v20 offset:6912
    ds_read_b64_tr_b16 a[40:41], v24 offset:0
    ds_read_b64_tr_b16 a[42:43], v24 offset:768
    v_mfma_f32_16x16x32_bf16 v[152:155], a[16:19], a[52:55], v[152:155]
    v_mfma_f32_16x16x32_bf16 v[156:159], a[16:19], a[56:59], v[156:159]
    ds_read_b128 a[72:75], v249 offset:0
    v_mfma_f32_16x16x32_bf16 v[160:163], a[16:19], a[60:63], v[160:163]
    v_mfma_f32_16x16x32_bf16 v[164:167], a[16:19], a[64:67], v[164:167]
    v_mfma_f32_16x16x32_bf16 a[120:123], a[68:71], a[68:71], a[120:123]
    ds_read_b64_tr_b16 a[4:5], v21 offset:6144
    ds_read_b64_tr_b16 a[6:7], v21 offset:6912
    v_mfma_f32_16x16x32_bf16 v[168:171], a[20:23], a[52:55], v[168:171]
    v_mfma_f32_16x16x32_bf16 v[172:175], a[20:23], a[56:59], v[172:175]
    ds_read_b128 a[76:79], v249 offset:2048
    v_mfma_f32_16x16x32_bf16 v[176:179], a[20:23], a[60:63], v[176:179]
    v_mfma_f32_16x16x32_bf16 v[180:183], a[20:23], a[64:67], v[180:183]
    s_waitcnt lgkmcnt(4)
    v_mfma_f32_16x16x32_bf16 a[100:103], a[40:43], a[68:71], a[100:103]
    ds_read_b64_tr_b16 a[8:9], v15 offset:8192
    ds_read_b64_tr_b16 a[10:11], v15 offset:9216
    ds_read_b64_tr_b16 a[44:45], v25 offset:0
    ds_read_b64_tr_b16 a[46:47], v25 offset:768
    v_mfma_f32_16x16x32_bf16 v[184:187], a[24:27], a[52:55], v[184:187]
    v_mfma_f32_16x16x32_bf16 v[188:191], a[24:27], a[56:59], v[188:191]
    ds_read_b128 a[80:83], v251 offset:0
    v_mfma_f32_16x16x32_bf16 v[192:195], a[24:27], a[60:63], v[192:195]
    v_mfma_f32_16x16x32_bf16 v[196:199], a[24:27], a[64:67], v[196:199]
    ds_read_b64_tr_b16 a[12:13], v16 offset:8192
    ds_read_b64_tr_b16 a[14:15], v16 offset:9216
    v_mfma_f32_16x16x32_bf16 v[200:203], a[28:31], a[52:55], v[200:203]
    v_mfma_f32_16x16x32_bf16 v[204:207], a[28:31], a[56:59], v[204:207]
    ds_read_b128 a[84:87], v251 offset:2048
    v_mfma_f32_16x16x32_bf16 v[208:211], a[28:31], a[60:63], v[208:211]
    v_mfma_f32_16x16x32_bf16 v[212:215], a[28:31], a[64:67], v[212:215]
    s_waitcnt lgkmcnt(4)
    v_mfma_f32_16x16x32_bf16 a[104:107], a[44:47], a[68:71], a[104:107]
    ds_read_b64_tr_b16 a[16:17], v17 offset:8192
    ds_read_b64_tr_b16 a[18:19], v17 offset:9216
    ds_read_b64_tr_b16 a[48:49], v26 offset:0
    ds_read_b64_tr_b16 a[50:51], v26 offset:768
    v_mfma_f32_16x16x32_bf16 v[216:219], a[0:3], a[52:55], v[216:219]
    v_mfma_f32_16x16x32_bf16 v[220:223], a[0:3], a[56:59], v[220:223]
    ds_read_b128 a[88:91], v253 offset:0
    v_mfma_f32_16x16x32_bf16 v[224:227], a[0:3], a[60:63], v[224:227]
    v_mfma_f32_16x16x32_bf16 v[228:231], a[0:3], a[64:67], v[228:231]
    ds_read_b64_tr_b16 a[20:21], v18 offset:8192
    ds_read_b64_tr_b16 a[22:23], v18 offset:9216
    v_mfma_f32_16x16x32_bf16 v[232:235], a[4:7], a[52:55], v[232:235]
    v_mfma_f32_16x16x32_bf16 v[236:239], a[4:7], a[56:59], v[236:239]
    v_mfma_f32_16x16x32_bf16 v[240:243], a[4:7], a[60:63], v[240:243]
    v_mfma_f32_16x16x32_bf16 v[244:247], a[4:7], a[64:67], v[244:247]
    s_waitcnt lgkmcnt(3)
    v_mfma_f32_16x16x32_bf16 a[108:111], a[48:51], a[68:71], a[108:111]
    s_waitcnt vmcnt(11)
    s_barrier
    ds_read_b64_tr_b16 a[24:25], v19 offset:12288
    ds_read_b64_tr_b16 a[26:27], v19 offset:13056
    ds_read_b64_tr_b16 a[32:33], v22 offset:8192
    ds_read_b64_tr_b16 a[34:35], v22 offset:9216
    s_waitcnt lgkmcnt(6)
    v_mfma_f32_16x16x32_bf16 v[88:91], a[8:11], a[72:75], v[88:91]
    v_mfma_f32_16x16x32_bf16 v[92:95], a[8:11], a[76:79], v[92:95]
    v_mfma_f32_16x16x32_bf16 v[96:99], a[8:11], a[80:83], v[96:99]
    v_mfma_f32_16x16x32_bf16 v[100:103], a[8:11], a[84:87], v[100:103]
    v_mfma_f32_16x16x32_bf16 a[112:115], a[72:75], a[72:75], a[112:115]
    s_add_u32 m0, s52, 0
    s_mul_i32 s49, s10, 98304
    s_mul_i32 s48, s10, 122880
    s_add_u32 s10, s10, 1
    s_cmp_eq_u32 s10, 20
    s_cselect_b32 s10, 0, s10
    buffer_load_dwordx4 v7, s[28:31], s49 offen offset:0 lds
    ds_read_b64_tr_b16 a[28:29], v20 offset:12288
    ds_read_b64_tr_b16 a[30:31], v20 offset:13056
    v_mfma_f32_16x16x32_bf16 v[104:107], a[12:15], a[72:75], v[104:107]
    v_mfma_f32_16x16x32_bf16 v[108:111], a[12:15], a[76:79], v[108:111]
    v_mfma_f32_16x16x32_bf16 v[112:115], a[12:15], a[80:83], v[112:115]
    v_mfma_f32_16x16x32_bf16 v[116:119], a[12:15], a[84:87], v[116:119]
    s_waitcnt lgkmcnt(2)
    v_mfma_f32_16x16x32_bf16 a[92:95], a[32:35], a[88:91], a[92:95]
    buffer_load_dwordx4 v8, s[28:31], s49 offen offset:1024 lds
    ds_read_b64_tr_b16 a[0:1], v21 offset:12288
    ds_read_b64_tr_b16 a[2:3], v21 offset:13056
    ds_read_b64_tr_b16 a[36:37], v23 offset:8192
    ds_read_b64_tr_b16 a[38:39], v23 offset:9216
    v_mfma_f32_16x16x32_bf16 v[120:123], a[16:19], a[72:75], v[120:123]
    v_mfma_f32_16x16x32_bf16 v[124:127], a[16:19], a[76:79], v[124:127]
    v_mfma_f32_16x16x32_bf16 v[128:131], a[16:19], a[80:83], v[128:131]
    v_mfma_f32_16x16x32_bf16 v[132:135], a[16:19], a[84:87], v[132:135]
    v_mfma_f32_16x16x32_bf16 a[116:119], a[76:79], a[76:79], a[116:119]
    buffer_load_dwordx4 v9, s[28:31], s49 offen offset:2048 lds
    ds_read_b64_tr_b16 a[4:5], v19 offset:18432
    ds_read_b64_tr_b16 a[6:7], v19 offset:19200
    v_mfma_f32_16x16x32_bf16 v[136:139], a[20:23], a[72:75], v[136:139]
    v_mfma_f32_16x16x32_bf16 v[140:143], a[20:23], a[76:79], v[140:143]
    v_mfma_f32_16x16x32_bf16 v[144:147], a[20:23], a[80:83], v[144:147]
    v_mfma_f32_16x16x32_bf16 v[148:151], a[20:23], a[84:87], v[148:151]
    s_waitcnt lgkmcnt(2)
    v_mfma_f32_16x16x32_bf16 a[96:99], a[36:39], a[88:91], a[96:99]
    s_add_u32 m0, s51, 0
    s_mov_b64 exec, s[44:45]
    buffer_load_dwordx4 v5, s[24:27], s48 offen offset:0 lds
    buffer_load_dwordx4 v6, s[24:27], s48 offen offset:1024 lds
    s_mov_b64 exec, -1
    ds_read_b64_tr_b16 a[8:9], v20 offset:18432
    ds_read_b64_tr_b16 a[10:11], v20 offset:19200
    ds_read_b64_tr_b16 a[40:41], v24 offset:12288
    ds_read_b64_tr_b16 a[42:43], v24 offset:13056
    v_mfma_f32_16x16x32_bf16 v[152:155], a[24:27], a[72:75], v[152:155]
    v_mfma_f32_16x16x32_bf16 v[156:159], a[24:27], a[76:79], v[156:159]
    ds_read_b128 a[52:55], v248 offset:18432
    v_mfma_f32_16x16x32_bf16 v[160:163], a[24:27], a[80:83], v[160:163]
    v_mfma_f32_16x16x32_bf16 v[164:167], a[24:27], a[84:87], v[164:167]
    v_mfma_f32_16x16x32_bf16 a[120:123], a[88:91], a[88:91], a[120:123]
    s_add_u32 m0, s53, 0
    s_mov_b32 s72, s11
    s_add_u32 s11, s11, 128
    s_cmp_eq_u32 s11, 1280
    s_cselect_b32 s11, 0, s11
    buffer_load_dwordx4 v10, s[20:23], s72 offen offset:0 lds
    ds_read_b64_tr_b16 a[12:13], v21 offset:18432
    ds_read_b64_tr_b16 a[14:15], v21 offset:19200
    v_mfma_f32_16x16x32_bf16 v[168:171], a[28:31], a[72:75], v[168:171]
    v_mfma_f32_16x16x32_bf16 v[172:175], a[28:31], a[76:79], v[172:175]
    ds_read_b128 a[56:59], v248 offset:20480
    v_mfma_f32_16x16x32_bf16 v[176:179], a[28:31], a[80:83], v[176:179]
    v_mfma_f32_16x16x32_bf16 v[180:183], a[28:31], a[84:87], v[180:183]
    s_waitcnt lgkmcnt(4)
    v_mfma_f32_16x16x32_bf16 a[100:103], a[40:43], a[88:91], a[100:103]
    buffer_load_dwordx4 v11, s[20:23], s72 offen offset:1024 lds
    ds_read_b64_tr_b16 a[16:17], v15 offset:16384
    ds_read_b64_tr_b16 a[18:19], v15 offset:17408
    ds_read_b64_tr_b16 a[44:45], v25 offset:12288
    ds_read_b64_tr_b16 a[46:47], v25 offset:13056
    v_mfma_f32_16x16x32_bf16 v[184:187], a[0:3], a[72:75], v[184:187]
    v_mfma_f32_16x16x32_bf16 v[188:191], a[0:3], a[76:79], v[188:191]
    ds_read_b128 a[60:63], v250 offset:18432
    v_mfma_f32_16x16x32_bf16 v[192:195], a[0:3], a[80:83], v[192:195]
    v_mfma_f32_16x16x32_bf16 v[196:199], a[0:3], a[84:87], v[196:199]
    buffer_load_dwordx4 v12, s[20:23], s72 offen offset:2048 lds
    ds_read_b64_tr_b16 a[20:21], v16 offset:16384
    ds_read_b64_tr_b16 a[22:23], v16 offset:17408
    v_mfma_f32_16x16x32_bf16 v[200:203], a[4:7], a[72:75], v[200:203]
    v_mfma_f32_16x16x32_bf16 v[204:207], a[4:7], a[76:79], v[204:207]
    ds_read_b128 a[64:67], v250 offset:20480
    v_mfma_f32_16x16x32_bf16 v[208:211], a[4:7], a[80:83], v[208:211]
    v_mfma_f32_16x16x32_bf16 v[212:215], a[4:7], a[84:87], v[212:215]
    s_waitcnt lgkmcnt(4)
    v_mfma_f32_16x16x32_bf16 a[104:107], a[44:47], a[88:91], a[104:107]
    buffer_load_dwordx4 v13, s[20:23], s72 offen offset:3072 lds
    ds_read_b64_tr_b16 a[24:25], v17 offset:16384
    ds_read_b64_tr_b16 a[26:27], v17 offset:17408
    ds_read_b64_tr_b16 a[48:49], v26 offset:12288
    ds_read_b64_tr_b16 a[50:51], v26 offset:13056
    v_mfma_f32_16x16x32_bf16 v[216:219], a[8:11], a[72:75], v[216:219]
    v_mfma_f32_16x16x32_bf16 v[220:223], a[8:11], a[76:79], v[220:223]
    ds_read_b128 a[68:71], v252 offset:18432
    v_mfma_f32_16x16x32_bf16 v[224:227], a[8:11], a[80:83], v[224:227]
    v_mfma_f32_16x16x32_bf16 v[228:231], a[8:11], a[84:87], v[228:231]
    s_add_u32 m0, s50, 0
    s_mov_b64 exec, s[46:47]
    buffer_load_dwordx4 v14, s[20:23], s72 offen lds
    s_mov_b64 exec, -1
    ds_read_b64_tr_b16 a[28:29], v18 offset:16384
    ds_read_b64_tr_b16 a[30:31], v18 offset:17408
    v_mfma_f32_16x16x32_bf16 v[232:235], a[12:15], a[72:75], v[232:235]
    v_mfma_f32_16x16x32_bf16 v[236:239], a[12:15], a[76:79], v[236:239]
    v_mfma_f32_16x16x32_bf16 v[240:243], a[12:15], a[80:83], v[240:243]
    v_mfma_f32_16x16x32_bf16 v[244:247], a[12:15], a[84:87], v[244:247]
    s_waitcnt lgkmcnt(3)
    v_mfma_f32_16x16x32_bf16 a[108:111], a[48:51], a[88:91], a[108:111]
    s_waitcnt vmcnt(10)
    s_barrier
    ds_read_b64_tr_b16 a[0:1], v19 offset:24576
    ds_read_b64_tr_b16 a[2:3], v19 offset:25344
    ds_read_b64_tr_b16 a[32:33], v22 offset:16384
    ds_read_b64_tr_b16 a[34:35], v22 offset:17408
    s_waitcnt lgkmcnt(6)
    v_mfma_f32_16x16x32_bf16 v[88:91], a[16:19], a[52:55], v[88:91]
    v_mfma_f32_16x16x32_bf16 v[92:95], a[16:19], a[56:59], v[92:95]
    s_mov_b32 s61, 0
    s_cmp_eq_u32 s98, 0
    s_cbranch_scc1 k1_hn
k1_hl:
    buffer_store_dwordx4 v[54:57], v53, s[64:67], 0 offen sc1
    v_cmp_ne_u32 vcc, 0xff, v0
    s_nop 1
    s_mov_b64 s[62:63], vcc
    v_cmp_eq_u32 vcc, 0, v54
    s_nop 1
    s_and_b64 vcc, vcc, s[62:63]
    s_cbranch_vccz k1_hd
    buffer_load_dwordx4 v[54:57], v52, s[64:67], 0 offen sc1
    s_waitcnt vmcnt(0)
    s_add_u32 s61, s61, 1
    s_cmp_lt_u32 s61, 50000
    s_cbranch_scc1 k1_hl
    s_branch k1_hd
k1_hn:
    v_readfirstlane_b32 s60, v54
    s_cmp_eq_u32 s60, s96
    s_cbranch_scc1 k1_hd
    s_mov_b64 exec, 1
    buffer_store_dwordx4 v[58:61], v53, s[64:67], 0 offen sc1
    buffer_load_dwordx4 v[54:57], v52, s[64:67], 0 offen sc1
    s_waitcnt vmcnt(0)
    s_mov_b64 exec, -1
    s_add_u32 s61, s61, 1
    s_cmp_lt_u32 s61, 50000
    s_cbranch_scc1 k1_hn
k1_hd:
    s_mov_b64 exec, 1
    buffer_atomic_add v50, v27, s[64:67], 0 offen
    s_mov_b64 exec, -1
    v_mfma_f32_16x16x32_bf16 v[96:99], a[16:19], a[60:63], v[96:99]
    v_mfma_f32_16x16x32_bf16 v[100:103], a[16:19], a[64:67], v[100:103]
    v_mfma_f32_16x16x32_bf16 a[112:115], a[52:55], a[52:55], a[112:115]
    s_add_u32 m0, s52, 12288
    s_mul_i32 s49, s10, 98304
    s_mul_i32 s48, s10, 122880
    s_add_u32 s10, s10, 1
    s_cmp_eq_u32 s10, 20
    s_cselect_b32 s10, 0, s10
    buffer_load_dwordx4 v7, s[28:31], s49 offen offset:0 lds
    ds_read_b64_tr_b16 a[4:5], v20 offset:24576
    ds_read_b64_tr_b16 a[6:7], v20 offset:25344
    v_mfma_f32_16x16x32_bf16 v[104:107], a[20:23], a[52:55], v[104:107]
    v_mfma_f32_16x16x32_bf16 v[108:111], a[20:23], a[56:59], v[108:111]
    v_mfma_f32_16x16x32_bf16 v[112:115], a[20:23], a[60:63], v[112:115]
    v_mfma_f32_16x16x32_bf16 v[116:119], a[20:23], a[64:67], v[116:119]
    s_waitcnt lgkmcnt(2)
    v_mfma_f32_16x16x32_bf16 a[92:95], a[32:35], a[68:71], a[92:95]
    buffer_load_dwordx4 v8, s[28:31], s49 offen offset:1024 lds
    ds_read_b64_tr_b16 a[8:9], v21 offset:24576
    ds_read_b64_tr_b16 a[10:11], v21 offset:25344
    ds_read_b64_tr_b16 a[36:37], v23 offset:16384
    ds_read_b64_tr_b16 a[38:39], v23 offset:17408
    v_mfma_f32_16x16x32_bf16 v[120:123], a[24:27], a[52:55], v[120:123]
    v_mfma_f32_16x16x32_bf16 v[124:127], a[24:27], a[56:59], v[124:127]
    v_mfma_f32_16x16x32_bf16 v[128:131], a[24:27], a[60:63], v[128:131]
    v_mfma_f32_16x16x32_bf16 v[132:135], a[24:27], a[64:67], v[132:135]
    v_mfma_f32_16x16x32_bf16 a[116:119], a[56:59], a[56:59], a[116:119]
    buffer_load_dwordx4 v9, s[28:31], s49 offen offset:2048 lds
    ds_read_b64_tr_b16 a[12:13], v19 offset:30720
    ds_read_b64_tr_b16 a[14:15], v19 offset:31488
    v_mfma_f32_16x16x32_bf16 v[136:139], a[28:31], a[52:55], v[136:139]
    v_mfma_f32_16x16x32_bf16 v[140:143], a[28:31], a[56:59], v[140:143]
    v_mfma_f32_16x16x32_bf16 v[144:147], a[28:31], a[60:63], v[144:147]
    v_mfma_f32_16x16x32_bf16 v[148:151], a[28:31], a[64:67], v[148:151]
    s_waitcnt lgkmcnt(2)
    v_mfma_f32_16x16x32_bf16 a[96:99], a[36:39], a[68:71], a[96:99]
    s_add_u32 m0, s51, 8192
    s_mov_b64 exec, s[44:45]
    buffer_load_dwordx4 v5, s[24:27], s48 offen offset:0 lds
    buffer_load_dwordx4 v6, s[24:27], s48 offen offset:1024 lds
    s_mov_b64 exec, -1
    ds_read_b64_tr_b16 a[16:17], v20 offset:30720
    ds_read_b64_tr_b16 a[18:19], v20 offset:31488
    ds_read_b64_tr_b16 a[40:41], v24 offset:24576
    ds_read_b64_tr_b16 a[42:43], v24 offset:25344
    v_mfma_f32_16x16x32_bf16 v[152:155], a[0:3], a[52:55], v[152:155]
    v_mfma_f32_16x16x32_bf16 v[156:159], a[0:3], a[56:59], v[156:159]
    ds_read_b128 a[72:75], v249 offset:18432
    v_mfma_f32_16x16x32_bf16 v[160:163], a[0:3], a[60:63], v[160:163]
    v_mfma_f32_16x16x32_bf16 v[164:167], a[0:3], a[64:67], v[164:167]
    v_mfma_f32_16x16x32_bf16 a[120:123], a[68:71], a[68:71], a[120:123]
    ds_read_b64_tr_b16 a[20:21], v21 offset:30720
    ds_read_b64_tr_b16 a[22:23], v21 offset:31488
    v_mfma_f32_16x16x32_bf16 v[168:171], a[4:7], a[52:55], v[168:171]
    v_mfma_f32_16x16x32_bf16 v[172:175], a[4:7], a[56:59], v[172:175]
    ds_read_b128 a[76:79], v249 offset:20480
    v_mfma_f32_16x16x32_bf16 v[176:179], a[4:7], a[60:63], v[176:179]
    v_mfma_f32_16x16x32_bf16 v[180:183], a[4:7], a[64:67], v[180:183]
    s_waitcnt lgkmcnt(4)
    v_mfma_f32_16x16x32_bf16 a[100:103], a[40:43], a[68:71], a[100:103]
    ds_read_b64_tr_b16 a[24:25], v15 offset:24576
    ds_read_b64_tr_b16 a[26:27], v15 offset:25600
    ds_read_b64_tr_b16 a[44:45], v25 offset:24576
    ds_read_b64_tr_b16 a[46:47], v25 offset:25344
    v_mfma_f32_16x16x32_bf16 v[184:187], a[8:11], a[52:55], v[184:187]
    v_mfma_f32_16x16x32_bf16 v[188:191], a[8:11], a[56:59], v[188:191]
    ds_read_b128 a[80:83], v251 offset:18432
    v_mfma_f32_16x16x32_bf16 v[192:195], a[8:11], a[60:63], v[192:195]
    v_mfma_f32_16x16x32_bf16 v[196:199], a[8:11], a[64:67], v[196:199]
    ds_read_b64_tr_b16 a[28:29], v16 offset:24576
    ds_read_b64_tr_b16 a[30:31], v16 offset:25600
    v_mfma_f32_16x16x32_bf16 v[200:203], a[12:15], a[52:55], v[200:203]
    v_mfma_f32_16x16x32_bf16 v[204:207], a[12:15], a[56:59], v[204:207]
    ds_read_b128 a[84:87], v251 offset:20480
    v_mfma_f32_16x16x32_bf16 v[208:211], a[12:15], a[60:63], v[208:211]
    v_mfma_f32_16x16x32_bf16 v[212:215], a[12:15], a[64:67], v[212:215]
    s_waitcnt lgkmcnt(4)
    v_mfma_f32_16x16x32_bf16 a[104:107], a[44:47], a[68:71], a[104:107]
    ds_read_b64_tr_b16 a[0:1], v17 offset:24576
    ds_read_b64_tr_b16 a[2:3], v17 offset:25600
    ds_read_b64_tr_b16 a[48:49], v26 offset:24576
    ds_read_b64_tr_b16 a[50:51], v26 offset:25344
    v_mfma_f32_16x16x32_bf16 v[216:219], a[16:19], a[52:55], v[216:219]
    v_mfma_f32_16x16x32_bf16 v[220:223], a[16:19], a[56:59], v[220:223]
    ds_read_b128 a[88:91], v253 offset:18432
    v_mfma_f32_16x16x32_bf16 v[224:227], a[16:19], a[60:63], v[224:227]
    v_mfma_f32_16x16x32_bf16 v[228:231], a[16:19], a[64:67], v[228:231]
    ds_read_b64_tr_b16 a[4:5], v18 offset:24576
    ds_read_b64_tr_b16 a[6:7], v18 offset:25600
    v_mfma_f32_16x16x32_bf16 v[232:235], a[20:23], a[52:55], v[232:235]
    v_mfma_f32_16x16x32_bf16 v[236:239], a[20:23], a[56:59], v[236:239]
    v_mfma_f32_16x16x32_bf16 v[240:243], a[20:23], a[60:63], v[240:243]
    v_mfma_f32_16x16x32_bf16 v[244:247], a[20:23], a[64:67], v[244:247]
    s_waitcnt lgkmcnt(3)
    v_mfma_f32_16x16x32_bf16 a[108:111], a[48:51], a[68:71], a[108:111]
    s_waitcnt vmcnt(11)
    s_barrier
    ds_read_b64_tr_b16 a[8:9], v19 offset:36864
    ds_read_b64_tr_b16 a[10:11], v19 offset:37632
    ds_read_b64_tr_b16 a[32:33], v22 offset:24576
    ds_read_b64_tr_b16 a[34:35], v22 offset:25600
    s_waitcnt lgkmcnt(6)
    v_mfma_f32_16x16x32_bf16 v[88:91], a[24:27], a[72:75], v[88:91]
    v_mfma_f32_16x16x32_bf16 v[92:95], a[24:27], a[76:79], v[92:95]
    v_mfma_f32_16x16x32_bf16 v[96:99], a[24:27], a[80:83], v[96:99]
    v_mfma_f32_16x16x32_bf16 v[100:103], a[24:27], a[84:87], v[100:103]
    v_mfma_f32_16x16x32_bf16 a[112:115], a[72:75], a[72:75], a[112:115]
    s_add_u32 m0, s52, 24576
    s_mul_i32 s49, s10, 98304
    s_mul_i32 s48, s10, 122880
    s_add_u32 s10, s10, 1
    s_cmp_eq_u32 s10, 20
    s_cselect_b32 s10, 0, s10
    buffer_load_dwordx4 v7, s[28:31], s49 offen offset:0 lds
    ds_read_b64_tr_b16 a[12:13], v20 offset:36864
    ds_read_b64_tr_b16 a[14:15], v20 offset:37632
    v_mfma_f32_16x16x32_bf16 v[104:107], a[28:31], a[72:75], v[104:107]
    v_mfma_f32_16x16x32_bf16 v[108:111], a[28:31], a[76:79], v[108:111]
    v_mfma_f32_16x16x32_bf16 v[112:115], a[28:31], a[80:83], v[112:115]
    v_mfma_f32_16x16x32_bf16 v[116:119], a[28:31], a[84:87], v[116:119]
    s_waitcnt lgkmcnt(2)
    v_mfma_f32_16x16x32_bf16 a[92:95], a[32:35], a[88:91], a[92:95]
    buffer_load_dwordx4 v8, s[28:31], s49 offen offset:1024 lds
    ds_read_b64_tr_b16 a[16:17], v21 offset:36864
    ds_read_b64_tr_b16 a[18:19], v21 offset:37632
    ds_read_b64_tr_b16 a[36:37], v23 offset:24576
    ds_read_b64_tr_b16 a[38:39], v23 offset:25600
    v_mfma_f32_16x16x32_bf16 v[120:123], a[0:3], a[72:75], v[120:123]
    v_mfma_f32_16x16x32_bf16 v[124:127], a[0:3], a[76:79], v[124:127]
    v_mfma_f32_16x16x32_bf16 v[128:131], a[0:3], a[80:83], v[128:131]
    v_mfma_f32_16x16x32_bf16 v[132:135], a[0:3], a[84:87], v[132:135]
    v_mfma_f32_16x16x32_bf16 a[116:119], a[76:79], a[76:79], a[116:119]
    buffer_load_dwordx4 v9, s[28:31], s49 offen offset:2048 lds
    ds_read_b64_tr_b16 a[20:21], v19 offset:43008
    ds_read_b64_tr_b16 a[22:23], v19 offset:43776
    v_mfma_f32_16x16x32_bf16 v[136:139], a[4:7], a[72:75], v[136:139]
    v_mfma_f32_16x16x32_bf16 v[140:143], a[4:7], a[76:79], v[140:143]
    v_mfma_f32_16x16x32_bf16 v[144:147], a[4:7], a[80:83], v[144:147]
    v_mfma_f32_16x16x32_bf16 v[148:151], a[4:7], a[84:87], v[148:151]
    s_waitcnt lgkmcnt(2)
    v_mfma_f32_16x16x32_bf16 a[96:99], a[36:39], a[88:91], a[96:99]
    s_add_u32 m0, s51, 16384
    s_mov_b64 exec, s[44:45]
    buffer_load_dwordx4 v5, s[24:27], s48 offen offset:0 lds
    buffer_load_dwordx4 v6, s[24:27], s48 offen offset:1024 lds
    s_mov_b64 exec, -1
    ds_read_b64_tr_b16 a[24:25], v20 offset:43008
    ds_read_b64_tr_b16 a[26:27], v20 offset:43776
    ds_read_b64_tr_b16 a[40:41], v24 offset:36864
    ds_read_b64_tr_b16 a[42:43], v24 offset:37632
    v_mfma_f32_16x16x32_bf16 v[152:155], a[8:11], a[72:75], v[152:155]
    v_mfma_f32_16x16x32_bf16 v[156:159], a[8:11], a[76:79], v[156:159]
    ds_read_b128 a[52:55], v248 offset:36864
    v_mfma_f32_16x16x32_bf16 v[160:163], a[8:11], a[80:83], v[160:163]
    v_mfma_f32_16x16x32_bf16 v[164:167], a[8:11], a[84:87], v[164:167]
    v_mfma_f32_16x16x32_bf16 a[120:123], a[88:91], a[88:91], a[120:123]
    ds_read_b64_tr_b16 a[28:29], v21 offset:43008
    ds_read_b64_tr_b16 a[30:31], v21 offset:43776
    v_mfma_f32_16x16x32_bf16 v[168:171], a[12:15], a[72:75], v[168:171]
    v_mfma_f32_16x16x32_bf16 v[172:175], a[12:15], a[76:79], v[172:175]
    ds_read_b128 a[56:59], v248 offset:38912
    v_mfma_f32_16x16x32_bf16 v[176:179], a[12:15], a[80:83], v[176:179]
    v_mfma_f32_16x16x32_bf16 v[180:183], a[12:15], a[84:87], v[180:183]
    s_waitcnt lgkmcnt(4)
    v_mfma_f32_16x16x32_bf16 a[100:103], a[40:43], a[88:91], a[100:103]
    ds_read_b64_tr_b16 a[0:1], v15 offset:0
    ds_read_b64_tr_b16 a[2:3], v15 offset:1024
    ds_read_b64_tr_b16 a[44:45], v25 offset:36864
    ds_read_b64_tr_b16 a[46:47], v25 offset:37632
    v_mfma_f32_16x16x32_bf16 v[184:187], a[16:19], a[72:75], v[184:187]
    v_mfma_f32_16x16x32_bf16 v[188:191], a[16:19], a[76:79], v[188:191]
    ds_read_b128 a[60:63], v250 offset:36864
    v_mfma_f32_16x16x32_bf16 v[192:195], a[16:19], a[80:83], v[192:195]
    v_mfma_f32_16x16x32_bf16 v[196:199], a[16:19], a[84:87], v[196:199]
    ds_read_b64_tr_b16 a[4:5], v16 offset:0
    ds_read_b64_tr_b16 a[6:7], v16 offset:1024
    v_mfma_f32_16x16x32_bf16 v[200:203], a[20:23], a[72:75], v[200:203]
    v_mfma_f32_16x16x32_bf16 v[204:207], a[20:23], a[76:79], v[204:207]
    ds_read_b128 a[64:67], v250 offset:38912
    v_mfma_f32_16x16x32_bf16 v[208:211], a[20:23], a[80:83], v[208:211]
    v_mfma_f32_16x16x32_bf16 v[212:215], a[20:23], a[84:87], v[212:215]
    s_waitcnt lgkmcnt(4)
    v_mfma_f32_16x16x32_bf16 a[104:107], a[44:47], a[88:91], a[104:107]
    ds_read_b64_tr_b16 a[8:9], v17 offset:0
    ds_read_b64_tr_b16 a[10:11], v17 offset:1024
    ds_read_b64_tr_b16 a[48:49], v26 offset:36864
    ds_read_b64_tr_b16 a[50:51], v26 offset:37632
    v_mfma_f32_16x16x32_bf16 v[216:219], a[24:27], a[72:75], v[216:219]
    v_mfma_f32_16x16x32_bf16 v[220:223], a[24:27], a[76:79], v[220:223]
    ds_read_b128 a[68:71], v252 offset:36864
    v_mfma_f32_16x16x32_bf16 v[224:227], a[24:27], a[80:83], v[224:227]
    v_mfma_f32_16x16x32_bf16 v[228:231], a[24:27], a[84:87], v[228:231]
    ds_read_b64_tr_b16 a[12:13], v18 offset:0
    ds_read_b64_tr_b16 a[14:15], v18 offset:1024
    v_mfma_f32_16x16x32_bf16 v[232:235], a[28:31], a[72:75], v[232:235]
    v_mfma_f32_16x16x32_bf16 v[236:239], a[28:31], a[76:79], v[236:239]
    v_mfma_f32_16x16x32_bf16 v[240:243], a[28:31], a[80:83], v[240:243]
    v_mfma_f32_16x16x32_bf16 v[244:247], a[28:31], a[84:87], v[244:247]
    s_waitcnt lgkmcnt(3)
    v_mfma_f32_16x16x32_bf16 a[108:111], a[48:51], a[88:91], a[108:111]
    s_waitcnt vmcnt(5)
    s_barrier
    ds_read_b64_tr_b16 a[16:17], v19 offset:0
    ds_read_b64_tr_b16 a[18:19], v19 offset:768
    ds_read_b64_tr_b16 a[32:33], v22 offset:0
    ds_read_b64_tr_b16 a[34:35], v22 offset:1024
    s_waitcnt lgkmcnt(6)
    v_mfma_f32_16x16x32_bf16 v[88:91], a[0:3], a[52:55], v[88:91]
    v_mfma_f32_16x16x32_bf16 v[92:95], a[0:3], a[56:59], v[92:95]
    v_mfma_f32_16x16x32_bf16 v[96:99], a[0:3], a[60:63], v[96:99]
    v_mfma_f32_16x16x32_bf16 v[100:103], a[0:3], a[64:67], v[100:103]
    v_mfma_f32_16x16x32_bf16 a[112:115], a[52:55], a[52:55], a[112:115]
    s_add_u32 m0, s52, 36864
    s_mul_i32 s49, s10, 98304
    s_mul_i32 s48, s10, 122880
    s_add_u32 s10, s10, 1
    s_cmp_eq_u32 s10, 20
    s_cselect_b32 s10, 0, s10
    buffer_load_dwordx4 v7, s[28:31], s49 offen offset:0 lds
    ds_read_b64_tr_b16 a[20:21], v20 offset:0
    ds_read_b64_tr_b16 a[22:23], v20 offset:768
    v_mfma_f32_16x16x32_bf16 v[104:107], a[4:7], a[52:55], v[104:107]
    v_mfma_f32_16x16x32_bf16 v[108:111], a[4:7], a[56:59], v[108:111]
    v_mfma_f32_16x16x32_bf16 v[112:115], a[4:7], a[60:63], v[112:115]
    v_mfma_f32_16x16x32_bf16 v[116:119], a[4:7], a[64:67], v[116:119]
    s_waitcnt lgkmcnt(2)
    v_mfma_f32_16x16x32_bf16 a[92:95], a[32:35], a[68:71], a[92:95]
    buffer_load_dwordx4 v8, s[28:31], s49 offen offset:1024 lds
    ds_read_b64_tr_b16 a[24:25], v21 offset:0
    ds_read_b64_tr_b16 a[26:27], v21 offset:768
    ds_read_b64_tr_b16 a[36:37], v23 offset:0
    ds_read_b64_tr_b16 a[38:39], v23 offset:1024
    v_mfma_f32_16x16x32_bf16 v[120:123], a[8:11], a[52:55], v[120:123]
    v_mfma_f32_16x16x32_bf16 v[124:127], a[8:11], a[56:59], v[124:127]
    v_mfma_f32_16x16x32_bf16 v[128:131], a[8:11], a[60:63], v[128:131]
    v_mfma_f32_16x16x32_bf16 v[132:135], a[8:11], a[64:67], v[132:135]
    v_mfma_f32_16x16x32_bf16 a[116:119], a[56:59], a[56:59], a[116:119]
    buffer_load_dwordx4 v9, s[28:31], s49 offen offset:2048 lds
    ds_read_b64_tr_b16 a[28:29], v19 offset:6144
    ds_read_b64_tr_b16 a[30:31], v19 offset:6912
    v_mfma_f32_16x16x32_bf16 v[136:139], a[12:15], a[52:55], v[136:139]
    v_mfma_f32_16x16x32_bf16 v[140:143], a[12:15], a[56:59], v[140:143]
    v_mfma_f32_16x16x32_bf16 v[144:147], a[12:15], a[60:63], v[144:147]
    v_mfma_f32_16x16x32_bf16 v[148:151], a[12:15], a[64:67], v[148:151]
    s_waitcnt lgkmcnt(2)
    v_mfma_f32_16x16x32_bf16 a[96:99], a[36:39], a[68:71], a[96:99]
    s_add_u32 m0, s51, 24576
    s_mov_b64 exec, s[44:45]
    buffer_load_dwordx4 v5, s[24:27], s48 offen offset:0 lds
    buffer_load_dwordx4 v6, s[24:27], s48 offen offset:1024 lds
    s_mov_b64 exec, -1
    ds_read_b64_tr_b16 a[0:1], v20 offset:6144
    ds_read_b64_tr_b16 a[2:3], v20 offset:6912
    ds_read_b64_tr_b16 a[40:41], v24 offset:0
    ds_read_b64_tr_b16 a[42:43], v24 offset:768
    v_mfma_f32_16x16x32_bf16 v[152:155], a[16:19], a[52:55], v[152:155]
    v_mfma_f32_16x16x32_bf16 v[156:159], a[16:19], a[56:59], v[156:159]
    ds_read_b128 a[72:75], v249 offset:36864
    v_mfma_f32_16x16x32_bf16 v[160:163], a[16:19], a[60:63], v[160:163]
    v_mfma_f32_16x16x32_bf16 v[164:167], a[16:19], a[64:67], v[164:167]
    v_mfma_f32_16x16x32_bf16 a[120:123], a[68:71], a[68:71], a[120:123]
    ds_read_b64_tr_b16 a[4:5], v21 offset:6144
    ds_read_b64_tr_b16 a[6:7], v21 offset:6912
    v_mfma_f32_16x16x32_bf16 v[168:171], a[20:23], a[52:55], v[168:171]
    v_mfma_f32_16x16x32_bf16 v[172:175], a[20:23], a[56:59], v[172:175]
    ds_read_b128 a[76:79], v249 offset:38912
    v_mfma_f32_16x16x32_bf16 v[176:179], a[20:23], a[60:63], v[176:179]
    v_mfma_f32_16x16x32_bf16 v[180:183], a[20:23], a[64:67], v[180:183]
    s_waitcnt lgkmcnt(4)
    v_mfma_f32_16x16x32_bf16 a[100:103], a[40:43], a[68:71], a[100:103]
    ds_read_b64_tr_b16 a[8:9], v15 offset:8192
    ds_read_b64_tr_b16 a[10:11], v15 offset:9216
    ds_read_b64_tr_b16 a[44:45], v25 offset:0
    ds_read_b64_tr_b16 a[46:47], v25 offset:768
    v_mfma_f32_16x16x32_bf16 v[184:187], a[24:27], a[52:55], v[184:187]
    v_mfma_f32_16x16x32_bf16 v[188:191], a[24:27], a[56:59], v[188:191]
    ds_read_b128 a[80:83], v251 offset:36864
    v_mfma_f32_16x16x32_bf16 v[192:195], a[24:27], a[60:63], v[192:195]
    v_mfma_f32_16x16x32_bf16 v[196:199], a[24:27], a[64:67], v[196:199]
    ds_read_b64_tr_b16 a[12:13], v16 offset:8192
    ds_read_b64_tr_b16 a[14:15], v16 offset:9216
    v_mfma_f32_16x16x32_bf16 v[200:203], a[28:31], a[52:55], v[200:203]
    v_mfma_f32_16x16x32_bf16 v[204:207], a[28:31], a[56:59], v[204:207]
    ds_read_b128 a[84:87], v251 offset:38912
    v_mfma_f32_16x16x32_bf16 v[208:211], a[28:31], a[60:63], v[208:211]
    v_mfma_f32_16x16x32_bf16 v[212:215], a[28:31], a[64:67], v[212:215]
    s_waitcnt lgkmcnt(4)
    v_mfma_f32_16x16x32_bf16 a[104:107], a[44:47], a[68:71], a[104:107]
    ds_read_b64_tr_b16 a[16:17], v17 offset:8192
    ds_read_b64_tr_b16 a[18:19], v17 offset:9216
    ds_read_b64_tr_b16 a[48:49], v26 offset:0
    ds_read_b64_tr_b16 a[50:51], v26 offset:768
    v_mfma_f32_16x16x32_bf16 v[216:219], a[0:3], a[52:55], v[216:219]
    v_mfma_f32_16x16x32_bf16 v[220:223], a[0:3], a[56:59], v[220:223]
    ds_read_b128 a[88:91], v253 offset:36864
    v_mfma_f32_16x16x32_bf16 v[224:227], a[0:3], a[60:63], v[224:227]
    v_mfma_f32_16x16x32_bf16 v[228:231], a[0:3], a[64:67], v[228:231]
    ds_read_b64_tr_b16 a[20:21], v18 offset:8192
    ds_read_b64_tr_b16 a[22:23], v18 offset:9216
    v_mfma_f32_16x16x32_bf16 v[232:235], a[4:7], a[52:55], v[232:235]
    v_mfma_f32_16x16x32_bf16 v[236:239], a[4:7], a[56:59], v[236:239]
    v_mfma_f32_16x16x32_bf16 v[240:243], a[4:7], a[60:63], v[240:243]
    v_mfma_f32_16x16x32_bf16 v[244:247], a[4:7], a[64:67], v[244:247]
    s_waitcnt lgkmcnt(3)
    v_mfma_f32_16x16x32_bf16 a[108:111], a[48:51], a[68:71], a[108:111]
    s_waitcnt vmcnt(5)
    s_barrier
    ds_read_b64_tr_b16 a[24:25], v19 offset:12288
    ds_read_b64_tr_b16 a[26:27], v19 offset:13056
    ds_read_b64_tr_b16 a[32:33], v22 offset:8192
    ds_read_b64_tr_b16 a[34:35], v22 offset:9216
    s_waitcnt lgkmcnt(6)
    v_mfma_f32_16x16x32_bf16 v[88:91], a[8:11], a[72:75], v[88:91]
    v_mfma_f32_16x16x32_bf16 v[92:95], a[8:11], a[76:79], v[92:95]
    v_mfma_f32_16x16x32_bf16 v[96:99], a[8:11], a[80:83], v[96:99]
    v_mfma_f32_16x16x32_bf16 v[100:103], a[8:11], a[84:87], v[100:103]
    v_mfma_f32_16x16x32_bf16 a[112:115], a[72:75], a[72:75], a[112:115]
    ds_read_b64_tr_b16 a[28:29], v20 offset:12288
    ds_read_b64_tr_b16 a[30:31], v20 offset:13056
    v_mfma_f32_16x16x32_bf16 v[104:107], a[12:15], a[72:75], v[104:107]
    v_mfma_f32_16x16x32_bf16 v[108:111], a[12:15], a[76:79], v[108:111]
    v_mfma_f32_16x16x32_bf16 v[112:115], a[12:15], a[80:83], v[112:115]
    v_mfma_f32_16x16x32_bf16 v[116:119], a[12:15], a[84:87], v[116:119]
    s_waitcnt lgkmcnt(2)
    v_mfma_f32_16x16x32_bf16 a[92:95], a[32:35], a[88:91], a[92:95]
    ds_read_b64_tr_b16 a[0:1], v21 offset:12288
    ds_read_b64_tr_b16 a[2:3], v21 offset:13056
    ds_read_b64_tr_b16 a[36:37], v23 offset:8192
    ds_read_b64_tr_b16 a[38:39], v23 offset:9216
    v_mfma_f32_16x16x32_bf16 v[120:123], a[16:19], a[72:75], v[120:123]
    v_mfma_f32_16x16x32_bf16 v[124:127], a[16:19], a[76:79], v[124:127]
    v_mfma_f32_16x16x32_bf16 v[128:131], a[16:19], a[80:83], v[128:131]
    v_mfma_f32_16x16x32_bf16 v[132:135], a[16:19], a[84:87], v[132:135]
    v_mfma_f32_16x16x32_bf16 a[116:119], a[76:79], a[76:79], a[116:119]
    ds_read_b64_tr_b16 a[4:5], v19 offset:18432
    ds_read_b64_tr_b16 a[6:7], v19 offset:19200
    v_mfma_f32_16x16x32_bf16 v[136:139], a[20:23], a[72:75], v[136:139]
    v_mfma_f32_16x16x32_bf16 v[140:143], a[20:23], a[76:79], v[140:143]
    v_mfma_f32_16x16x32_bf16 v[144:147], a[20:23], a[80:83], v[144:147]
    v_mfma_f32_16x16x32_bf16 v[148:151], a[20:23], a[84:87], v[148:151]
    s_waitcnt lgkmcnt(2)
    v_mfma_f32_16x16x32_bf16 a[96:99], a[36:39], a[88:91], a[96:99]
    ds_read_b64_tr_b16 a[8:9], v20 offset:18432
    ds_read_b64_tr_b16 a[10:11], v20 offset:19200
    ds_read_b64_tr_b16 a[40:41], v24 offset:12288
    ds_read_b64_tr_b16 a[42:43], v24 offset:13056
    v_mfma_f32_16x16x32_bf16 v[152:155], a[24:27], a[72:75], v[152:155]
    v_mfma_f32_16x16x32_bf16 v[156:159], a[24:27], a[76:79], v[156:159]
    ds_read_b128 a[52:55], v248 offset:0
    v_mfma_f32_16x16x32_bf16 v[160:163], a[24:27], a[80:83], v[160:163]
    v_mfma_f32_16x16x32_bf16 v[164:167], a[24:27], a[84:87], v[164:167]
    v_mfma_f32_16x16x32_bf16 a[120:123], a[88:91], a[88:91], a[120:123]
    ds_read_b64_tr_b16 a[12:13], v21 offset:18432
    ds_read_b64_tr_b16 a[14:15], v21 offset:19200
    v_mfma_f32_16x16x32_bf16 v[168:171], a[28:31], a[72:75], v[168:171]
    v_mfma_f32_16x16x32_bf16 v[172:175], a[28:31], a[76:79], v[172:175]
    ds_read_b128 a[56:59], v248 offset:2048
    v_mfma_f32_16x16x32_bf16 v[176:179], a[28:31], a[80:83], v[176:179]
    v_mfma_f32_16x16x32_bf16 v[180:183], a[28:31], a[84:87], v[180:183]
    s_waitcnt lgkmcnt(4)
    v_mfma_f32_16x16x32_bf16 a[100:103], a[40:43], a[88:91], a[100:103]
    ds_read_b64_tr_b16 a[16:17], v15 offset:16384
    ds_read_b64_tr_b16 a[18:19], v15 offset:17408
    ds_read_b64_tr_b16 a[44:45], v25 offset:12288
    ds_read_b64_tr_b16 a[46:47], v25 offset:13056
    v_mfma_f32_16x16x32_bf16 v[184:187], a[0:3], a[72:75], v[184:187]
    v_mfma_f32_16x16x32_bf16 v[188:191], a[0:3], a[76:79], v[188:191]
    ds_read_b128 a[60:63], v250 offset:0
    v_mfma_f32_16x16x32_bf16 v[192:195], a[0:3], a[80:83], v[192:195]
    v_mfma_f32_16x16x32_bf16 v[196:199], a[0:3], a[84:87], v[196:199]
    ds_read_b64_tr_b16 a[20:21], v16 offset:16384
    ds_read_b64_tr_b16 a[22:23], v16 offset:17408
    v_mfma_f32_16x16x32_bf16 v[200:203], a[4:7], a[72:75], v[200:203]
    v_mfma_f32_16x16x32_bf16 v[204:207], a[4:7], a[76:79], v[204:207]
    ds_read_b128 a[64:67], v250 offset:2048
    v_mfma_f32_16x16x32_bf16 v[208:211], a[4:7], a[80:83], v[208:211]
    v_mfma_f32_16x16x32_bf16 v[212:215], a[4:7], a[84:87], v[212:215]
    s_waitcnt lgkmcnt(4)
    v_mfma_f32_16x16x32_bf16 a[104:107], a[44:47], a[88:91], a[104:107]
    ds_read_b64_tr_b16 a[24:25], v17 offset:16384
    ds_read_b64_tr_b16 a[26:27], v17 offset:17408
    ds_read_b64_tr_b16 a[48:49], v26 offset:12288
    ds_read_b64_tr_b16 a[50:51], v26 offset:13056
    v_mfma_f32_16x16x32_bf16 v[216:219], a[8:11], a[72:75], v[216:219]
    v_mfma_f32_16x16x32_bf16 v[220:223], a[8:11], a[76:79], v[220:223]
    ds_read_b128 a[68:71], v252 offset:0
    v_mfma_f32_16x16x32_bf16 v[224:227], a[8:11], a[80:83], v[224:227]
    v_mfma_f32_16x16x32_bf16 v[228:231], a[8:11], a[84:87], v[228:231]
    ds_read_b64_tr_b16 a[28:29], v18 offset:16384
    ds_read_b64_tr_b16 a[30:31], v18 offset:17408
    v_mfma_f32_16x16x32_bf16 v[232:235], a[12:15], a[72:75], v[232:235]
    v_mfma_f32_16x16x32_bf16 v[236:239], a[12:15], a[76:79], v[236:239]
    v_mfma_f32_16x16x32_bf16 v[240:243], a[12:15], a[80:83], v[240:243]
    v_mfma_f32_16x16x32_bf16 v[244:247], a[12:15], a[84:87], v[244:247]
    s_waitcnt lgkmcnt(3)
    v_mfma_f32_16x16x32_bf16 a[108:111], a[48:51], a[88:91], a[108:111]
    s_waitcnt vmcnt(0)
    s_barrier
    ds_read_b64_tr_b16 a[0:1], v19 offset:24576
    ds_read_b64_tr_b16 a[2:3], v19 offset:25344
    ds_read_b64_tr_b16 a[32:33], v22 offset:16384
    ds_read_b64_tr_b16 a[34:35], v22 offset:17408
    s_waitcnt lgkmcnt(6)
    v_mfma_f32_16x16x32_bf16 v[88:91], a[16:19], a[52:55], v[88:91]
    v_mfma_f32_16x16x32_bf16 v[92:95], a[16:19], a[56:59], v[92:95]
    v_mfma_f32_16x16x32_bf16 v[96:99], a[16:19], a[60:63], v[96:99]
    v_mfma_f32_16x16x32_bf16 v[100:103], a[16:19], a[64:67], v[100:103]
    v_mfma_f32_16x16x32_bf16 a[112:115], a[52:55], a[52:55], a[112:115]
    ds_read_b64_tr_b16 a[4:5], v20 offset:24576
    ds_read_b64_tr_b16 a[6:7], v20 offset:25344
    v_mfma_f32_16x16x32_bf16 v[104:107], a[20:23], a[52:55], v[104:107]
    v_mfma_f32_16x16x32_bf16 v[108:111], a[20:23], a[56:59], v[108:111]
    v_mfma_f32_16x16x32_bf16 v[112:115], a[20:23], a[60:63], v[112:115]
    v_mfma_f32_16x16x32_bf16 v[116:119], a[20:23], a[64:67], v[116:119]
    s_waitcnt lgkmcnt(2)
    v_mfma_f32_16x16x32_bf16 a[92:95], a[32:35], a[68:71], a[92:95]
    ds_read_b64_tr_b16 a[8:9], v21 offset:24576
    ds_read_b64_tr_b16 a[10:11], v21 offset:25344
    ds_read_b64_tr_b16 a[36:37], v23 offset:16384
    ds_read_b64_tr_b16 a[38:39], v23 offset:17408
    v_mfma_f32_16x16x32_bf16 v[120:123], a[24:27], a[52:55], v[120:123]
    v_mfma_f32_16x16x32_bf16 v[124:127], a[24:27], a[56:59], v[124:127]
    v_mfma_f32_16x16x32_bf16 v[128:131], a[24:27], a[60:63], v[128:131]
    v_mfma_f32_16x16x32_bf16 v[132:135], a[24:27], a[64:67], v[132:135]
    v_mfma_f32_16x16x32_bf16 a[116:119], a[56:59], a[56:59], a[116:119]
    ds_read_b64_tr_b16 a[12:13], v19 offset:30720
    ds_read_b64_tr_b16 a[14:15], v19 offset:31488
    v_mfma_f32_16x16x32_bf16 v[136:139], a[28:31], a[52:55], v[136:139]
    v_mfma_f32_16x16x32_bf16 v[140:143], a[28:31], a[56:59], v[140:143]
    v_mfma_f32_16x16x32_bf16 v[144:147], a[28:31], a[60:63], v[144:147]
    v_mfma_f32_16x16x32_bf16 v[148:151], a[28:31], a[64:67], v[148:151]
    s_waitcnt lgkmcnt(2)
    v_mfma_f32_16x16x32_bf16 a[96:99], a[36:39], a[68:71], a[96:99]
    ds_read_b64_tr_b16 a[16:17], v20 offset:30720
    ds_read_b64_tr_b16 a[18:19], v20 offset:31488
    ds_read_b64_tr_b16 a[40:41], v24 offset:24576
    ds_read_b64_tr_b16 a[42:43], v24 offset:25344
    v_mfma_f32_16x16x32_bf16 v[152:155], a[0:3], a[52:55], v[152:155]
    v_mfma_f32_16x16x32_bf16 v[156:159], a[0:3], a[56:59], v[156:159]
    ds_read_b128 a[72:75], v249 offset:0
    v_mfma_f32_16x16x32_bf16 v[160:163], a[0:3], a[60:63], v[160:163]
    v_mfma_f32_16x16x32_bf16 v[164:167], a[0:3], a[64:67], v[164:167]
    v_mfma_f32_16x16x32_bf16 a[120:123], a[68:71], a[68:71], a[120:123]
    ds_read_b64_tr_b16 a[20:21], v21 offset:30720
    ds_read_b64_tr_b16 a[22:23], v21 offset:31488
    v_mfma_f32_16x16x32_bf16 v[168:171], a[4:7], a[52:55], v[168:171]
    v_mfma_f32_16x16x32_bf16 v[172:175], a[4:7], a[56:59], v[172:175]
    ds_read_b128 a[76:79], v249 offset:2048
    v_mfma_f32_16x16x32_bf16 v[176:179], a[4:7], a[60:63], v[176:179]
    v_mfma_f32_16x16x32_bf16 v[180:183], a[4:7], a[64:67], v[180:183]
    s_waitcnt lgkmcnt(4)
    v_mfma_f32_16x16x32_bf16 a[100:103], a[40:43], a[68:71], a[100:103]
    ds_read_b64_tr_b16 a[24:25], v15 offset:24576
    ds_read_b64_tr_b16 a[26:27], v15 offset:25600
    ds_read_b64_tr_b16 a[44:45], v25 offset:24576
    ds_read_b64_tr_b16 a[46:47], v25 offset:25344
    v_mfma_f32_16x16x32_bf16 v[184:187], a[8:11], a[52:55], v[184:187]
    v_mfma_f32_16x16x32_bf16 v[188:191], a[8:11], a[56:59], v[188:191]
    ds_read_b128 a[80:83], v251 offset:0
    v_mfma_f32_16x16x32_bf16 v[192:195], a[8:11], a[60:63], v[192:195]
    v_mfma_f32_16x16x32_bf16 v[196:199], a[8:11], a[64:67], v[196:199]
    ds_read_b64_tr_b16 a[28:29], v16 offset:24576
    ds_read_b64_tr_b16 a[30:31], v16 offset:25600
    v_mfma_f32_16x16x32_bf16 v[200:203], a[12:15], a[52:55], v[200:203]
    v_mfma_f32_16x16x32_bf16 v[204:207], a[12:15], a[56:59], v[204:207]
    ds_read_b128 a[84:87], v251 offset:2048
    v_mfma_f32_16x16x32_bf16 v[208:211], a[12:15], a[60:63], v[208:211]
    v_mfma_f32_16x16x32_bf16 v[212:215], a[12:15], a[64:67], v[212:215]
    s_waitcnt lgkmcnt(4)
    v_mfma_f32_16x16x32_bf16 a[104:107], a[44:47], a[68:71], a[104:107]
    ds_read_b64_tr_b16 a[0:1], v17 offset:24576
    ds_read_b64_tr_b16 a[2:3], v17 offset:25600
    ds_read_b64_tr_b16 a[48:49], v26 offset:24576
    ds_read_b64_tr_b16 a[50:51], v26 offset:25344
    v_mfma_f32_16x16x32_bf16 v[216:219], a[16:19], a[52:55], v[216:219]
    v_mfma_f32_16x16x32_bf16 v[220:223], a[16:19], a[56:59], v[220:223]
    ds_read_b128 a[88:91], v253 offset:0
    v_mfma_f32_16x16x32_bf16 v[224:227], a[16:19], a[60:63], v[224:227]
    v_mfma_f32_16x16x32_bf16 v[228:231], a[16:19], a[64:67], v[228:231]
    ds_read_b64_tr_b16 a[4:5], v18 offset:24576
    ds_read_b64_tr_b16 a[6:7], v18 offset:25600
    v_mfma_f32_16x16x32_bf16 v[232:235], a[20:23], a[52:55], v[232:235]
    v_mfma_f32_16x16x32_bf16 v[236:239], a[20:23], a[56:59], v[236:239]
    v_mfma_f32_16x16x32_bf16 v[240:243], a[20:23], a[60:63], v[240:243]
    v_mfma_f32_16x16x32_bf16 v[244:247], a[20:23], a[64:67], v[244:247]
    s_waitcnt lgkmcnt(3)
    v_mfma_f32_16x16x32_bf16 a[108:111], a[48:51], a[68:71], a[108:111]
    ds_read_b64_tr_b16 a[8:9], v19 offset:36864
    ds_read_b64_tr_b16 a[10:11], v19 offset:37632
    ds_read_b64_tr_b16 a[32:33], v22 offset:24576
    ds_read_b64_tr_b16 a[34:35], v22 offset:25600
    s_waitcnt lgkmcnt(6)
    v_mfma_f32_16x16x32_bf16 v[88:91], a[24:27], a[72:75], v[88:91]
    v_mfma_f32_16x16x32_bf16 v[92:95], a[24:27], a[76:79], v[92:95]
    buffer_load_dword v51, v34, s[64:67], 0 offen sc1
    v_mfma_f32_16x16x32_bf16 v[96:99], a[24:27], a[80:83], v[96:99]
    v_mfma_f32_16x16x32_bf16 v[100:103], a[24:27], a[84:87], v[100:103]
    v_mfma_f32_16x16x32_bf16 a[112:115], a[72:75], a[72:75], a[112:115]
    ds_read_b64_tr_b16 a[12:13], v20 offset:36864
    ds_read_b64_tr_b16 a[14:15], v20 offset:37632
    v_mfma_f32_16x16x32_bf16 v[104:107], a[28:31], a[72:75], v[104:107]
    v_mfma_f32_16x16x32_bf16 v[108:111], a[28:31], a[76:79], v[108:111]
    v_mfma_f32_16x16x32_bf16 v[112:115], a[28:31], a[80:83], v[112:115]
    v_mfma_f32_16x16x32_bf16 v[116:119], a[28:31], a[84:87], v[116:119]
    s_waitcnt lgkmcnt(2)
    v_mfma_f32_16x16x32_bf16 a[92:95], a[32:35], a[88:91], a[92:95]
    ds_read_b64_tr_b16 a[16:17], v21 offset:36864
    ds_read_b64_tr_b16 a[18:19], v21 offset:37632
    ds_read_b64_tr_b16 a[36:37], v23 offset:24576
    ds_read_b64_tr_b16 a[38:39], v23 offset:25600
    v_mfma_f32_16x16x32_bf16 v[120:123], a[0:3], a[72:75], v[120:123]
    v_mfma_f32_16x16x32_bf16 v[124:127], a[0:3], a[76:79], v[124:127]
    v_mfma_f32_16x16x32_bf16 v[128:131], a[0:3], a[80:83], v[128:131]
    v_mfma_f32_16x16x32_bf16 v[132:135], a[0:3], a[84:87], v[132:135]
    v_mfma_f32_16x16x32_bf16 a[116:119], a[76:79], a[76:79], a[116:119]
    ds_read_b64_tr_b16 a[20:21], v19 offset:43008
    ds_read_b64_tr_b16 a[22:23], v19 offset:43776
    v_mfma_f32_16x16x32_bf16 v[136:139], a[4:7], a[72:75], v[136:139]
    v_mfma_f32_16x16x32_bf16 v[140:143], a[4:7], a[76:79], v[140:143]
    v_mfma_f32_16x16x32_bf16 v[144:147], a[4:7], a[80:83], v[144:147]
    v_mfma_f32_16x16x32_bf16 v[148:151], a[4:7], a[84:87], v[148:151]
    s_waitcnt lgkmcnt(2)
    v_mfma_f32_16x16x32_bf16 a[96:99], a[36:39], a[88:91], a[96:99]
    ds_read_b64_tr_b16 a[24:25], v20 offset:43008
    ds_read_b64_tr_b16 a[26:27], v20 offset:43776
    ds_read_b64_tr_b16 a[40:41], v24 offset:36864
    ds_read_b64_tr_b16 a[42:43], v24 offset:37632
    v_mfma_f32_16x16x32_bf16 v[152:155], a[8:11], a[72:75], v[152:155]
    v_mfma_f32_16x16x32_bf16 v[156:159], a[8:11], a[76:79], v[156:159]
    v_mfma_f32_16x16x32_bf16 v[160:163], a[8:11], a[80:83], v[160:163]
    v_mfma_f32_16x16x32_bf16 v[164:167], a[8:11], a[84:87], v[164:167]
    v_mfma_f32_16x16x32_bf16 a[120:123], a[88:91], a[88:91], a[120:123]
    ds_read_b64_tr_b16 a[28:29], v21 offset:43008
    ds_read_b64_tr_b16 a[30:31], v21 offset:43776
    v_mfma_f32_16x16x32_bf16 v[168:171], a[12:15], a[72:75], v[168:171]
    v_mfma_f32_16x16x32_bf16 v[172:175], a[12:15], a[76:79], v[172:175]
    v_mfma_f32_16x16x32_bf16 v[176:179], a[12:15], a[80:83], v[176:179]
    v_mfma_f32_16x16x32_bf16 v[180:183], a[12:15], a[84:87], v[180:183]
    s_waitcnt lgkmcnt(2)
    v_mfma_f32_16x16x32_bf16 a[100:103], a[40:43], a[88:91], a[100:103]
    ds_read_b64_tr_b16 a[44:45], v25 offset:36864
    ds_read_b64_tr_b16 a[46:47], v25 offset:37632
    v_mfma_f32_16x16x32_bf16 v[184:187], a[16:19], a[72:75], v[184:187]
    v_mfma_f32_16x16x32_bf16 v[188:191], a[16:19], a[76:79], v[188:191]
    v_mfma_f32_16x16x32_bf16 v[192:195], a[16:19], a[80:83], v[192:195]
    v_mfma_f32_16x16x32_bf16 v[196:199], a[16:19], a[84:87], v[196:199]
    v_mfma_f32_16x16x32_bf16 v[200:203], a[20:23], a[72:75], v[200:203]
    v_mfma_f32_16x16x32_bf16 v[204:207], a[20:23], a[76:79], v[204:207]
    v_mfma_f32_16x16x32_bf16 v[208:211], a[20:23], a[80:83], v[208:211]
    v_mfma_f32_16x16x32_bf16 v[212:215], a[20:23], a[84:87], v[212:215]
    s_waitcnt lgkmcnt(0)
    v_mfma_f32_16x16x32_bf16 a[104:107], a[44:47], a[88:91], a[104:107]
    ds_read_b64_tr_b16 a[48:49], v26 offset:36864
    ds_read_b64_tr_b16 a[50:51], v26 offset:37632
    v_mfma_f32_16x16x32_bf16 v[216:219], a[24:27], a[72:75], v[216:219]
    v_mfma_f32_16x16x32_bf16 v[220:223], a[24:27], a[76:79], v[220:223]
    v_mfma_f32_16x16x32_bf16 v[224:227], a[24:27], a[80:83], v[224:227]
    v_mfma_f32_16x16x32_bf16 v[228:231], a[24:27], a[84:87], v[228:231]
    v_mfma_f32_16x16x32_bf16 v[232:235], a[28:31], a[72:75], v[232:235]
    v_mfma_f32_16x16x32_bf16 v[236:239], a[28:31], a[76:79], v[236:239]
    v_mfma_f32_16x16x32_bf16 v[240:243], a[28:31], a[80:83], v[240:243]
    v_mfma_f32_16x16x32_bf16 v[244:247], a[28:31], a[84:87], v[244:247]
    s_waitcnt lgkmcnt(0)
    v_mfma_f32_16x16x32_bf16 a[108:111], a[48:51], a[88:91], a[108:111]
    s_nop 15
    s_lshl_b32 s17, s73, 6
    s_add_u32 s17, s17, 158016
    v_lshlrev_b32 v7, 2, v1
    v_add_u32 v5, s17, v7
    s_lshl_b32 s17, s74, 6
    s_add_u32 s17, s17, 158016
    v_add_u32 v6, s17, v7
    v_add_u32 v7, 157952, v7
    v_lshl_add_u32 v8, v3, 6, v7
    v_lshlrev_b32 v13, 4, v2
    v_add_u32 v13, 160128, v13
    v_lshl_add_u32 v9, v3, 7, v13
    v_mul_u32_u24 v10, 192, v3
    v_add_u32 v10, v10, v13
    v_add_u32 v10, 512, v10
    v_lshrrev_b32 v14, 1, v3
    v_lshl_add_u32 v11, v14, 8, v13
    v_mul_u32_u24 v12, 192, v14
    v_add_u32 v12, v12, v13
    v_add_u32 v12, 512, v12
    v_mul_u32_u24 v14, 640, v14
    v_add_u32 v15, v14, v5
    v_add_u32 v16, v14, v6
    s_mov_b32 exec_lo, 1048577
    s_mov_b32 exec_hi, 268435712
    ds_write_b32 v5, a112
    ds_write_b32 v5, a116 offset:64
    ds_write_b32 v7, a120
    s_mov_b32 exec_lo, 2097154
    s_mov_b32 exec_hi, 536871424
    ds_write_b32 v5, a113
    ds_write_b32 v5, a117 offset:64
    ds_write_b32 v7, a121
    s_mov_b32 exec_lo, 4194308
    s_mov_b32 exec_hi, 1073742848
    ds_write_b32 v5, a114
    ds_write_b32 v5, a118 offset:64
    ds_write_b32 v7, a122
    s_mov_b32 exec_lo, 8388616
    s_mov_b32 exec_hi, 2147485696
    ds_write_b32 v5, a115
    ds_write_b32 v5, a119 offset:64
    ds_write_b32 v7, a123
    s_mov_b32 exec_lo, 0
    s_mov_b32 exec_hi, 0xffff
    ds_write_b32 v15, v136 offset:640
    ds_write_b32 v15, v140 offset:704
    ds_write_b32 v16, v144 offset:640
    ds_write_b32 v16, v148 offset:704
    ds_write_b32 v8, a96 offset:1920
    s_mov_b32 exec_lo, 0x00010001
    s_mov_b32 exec_hi, 0x00010001
    ds_write_b128 v9, a[92:95] offset:0
    ds_write_b128 v9, a[96:99] offset:64
    ds_write_b128 v10, a[100:103] offset:0
    ds_write_b128 v10, a[104:107] offset:64
    ds_write_b128 v10, a[108:111] offset:128
    s_mov_b64 exec, -1
    s_waitcnt vmcnt(0)
    v_readfirstlane_b32 s60, v51
    s_cmp_ge_u32 s60, 68
    s_cbranch_scc1 k1_w_d
    s_mov_b32 s61, 0
k1_w_s:
    buffer_load_dword v51, v34, s[64:67], 0 offen sc1
    s_waitcnt vmcnt(0)
    v_readfirstlane_b32 s60, v51
    s_add_u32 s61, s61, 1
    s_cmp_ge_u32 s60, 68
    s_cbranch_scc1 k1_w_d
    s_cmp_lt_u32 s61, 50000
    s_cbranch_scc1 k1_w_s
k1_w_d:
    s_waitcnt lgkmcnt(0)
    s_barrier
    s_mul_i32 s10, s81, 3
    s_lshr_b32 s10, s10, 1
    s_mul_i32 s11, s81, 5
    s_lshr_b32 s11, s11, 3
    v_add_u32 v29, 4096, v47
    ds_read_b32 v18, v5 offset:1280
    ds_read_b32 v19, v5 offset:1344
    ds_read_b32 v20, v6 offset:1280
    ds_read_b32 v21, v6 offset:1344
    ds_read_b32 v22, v7 offset:2112
    ds_read_b32 v24, v5 offset:0
    ds_read_b32 v25, v5 offset:64
    ds_read_b32 v26, v6 offset:0
    ds_read_b32 v27, v6 offset:64
    ds_read_b32 v28, v7
    ds_read_b128 v[84:87], v9 offset:0
    ds_read_b128 v[80:83], v9 offset:64
    ds_read_b128 v[52:55], v12 offset:0
    ds_read_b128 v[56:59], v12 offset:384
    ds_read_b128 v[60:63], v12 offset:64
    s_mov_b32 s48, 102400
    buffer_load_dwordx4 a[0:3], v47, s[68:71], s48 offen offset:0
    buffer_load_dwordx4 a[4:7], v47, s[68:71], s48 offen offset:1024
    buffer_load_dwordx4 a[8:11], v47, s[68:71], s48 offen offset:2048
    buffer_load_dwordx4 a[12:15], v47, s[68:71], s48 offen offset:3072
    buffer_load_dwordx4 a[16:19], v29, s[68:71], s48 offen offset:0
    s_mov_b32 s48, 122880
    buffer_load_dwordx4 a[20:23], v47, s[68:71], s48 offen offset:0
    buffer_load_dwordx4 a[24:27], v47, s[68:71], s48 offen offset:1024
    buffer_load_dwordx4 a[28:31], v47, s[68:71], s48 offen offset:2048
    buffer_load_dwordx4 a[32:35], v47, s[68:71], s48 offen offset:3072
    buffer_load_dwordx4 a[36:39], v29, s[68:71], s48 offen offset:0
    s_waitcnt lgkmcnt(5)
    v_mul_f32 v18, 0x3acccccd, v18
    v_mul_f32 v24, 0x3acccccd, v24
    v_fma_f32 v24, -v18, v18, v24
    v_max_f32 v24, 0, v24
    v_cvt_pk_bf16_f32 v14, v18, v18
    v_lshlrev_b32 v18, 16, v14
    v_cvt_pk_bf16_f32 v14, v24, v24
    v_lshlrev_b32 v24, 16, v14
    v_add_f32 v24, 0x3727c5ac, v24
    v_cvt_pk_bf16_f32 v14, v24, v24
    v_lshlrev_b32 v24, 16, v14
    v_sqrt_f32 v24, v24
    s_nop 0
    v_cvt_pk_bf16_f32 v14, v24, v24
    v_lshlrev_b32 v24, 16, v14
    v_rcp_f32 v24, v24
    v_sub_f32 v18, 0, v18
    v_mul_f32 v19, 0x3acccccd, v19
    v_mul_f32 v25, 0x3acccccd, v25
    v_fma_f32 v25, -v19, v19, v25
    v_max_f32 v25, 0, v25
    v_cvt_pk_bf16_f32 v14, v19, v19
    v_lshlrev_b32 v19, 16, v14
    v_cvt_pk_bf16_f32 v14, v25, v25
    v_lshlrev_b32 v25, 16, v14
    v_add_f32 v25, 0x3727c5ac, v25
    v_cvt_pk_bf16_f32 v14, v25, v25
    v_lshlrev_b32 v25, 16, v14
    v_sqrt_f32 v25, v25
    s_nop 0
    v_cvt_pk_bf16_f32 v14, v25, v25
    v_lshlrev_b32 v25, 16, v14
    v_rcp_f32 v25, v25
    v_sub_f32 v19, 0, v19
    v_mul_f32 v20, 0x3acccccd, v20
    v_mul_f32 v26, 0x3acccccd, v26
    v_fma_f32 v26, -v20, v20, v26
    v_max_f32 v26, 0, v26
    v_cvt_pk_bf16_f32 v14, v20, v20
    v_lshlrev_b32 v20, 16, v14
    v_cvt_pk_bf16_f32 v14, v26, v26
    v_lshlrev_b32 v26, 16, v14
    v_add_f32 v26, 0x3727c5ac, v26
    v_cvt_pk_bf16_f32 v14, v26, v26
    v_lshlrev_b32 v26, 16, v14
    v_sqrt_f32 v26, v26
    s_nop 0
    v_cvt_pk_bf16_f32 v14, v26, v26
    v_lshlrev_b32 v26, 16, v14
    v_rcp_f32 v26, v26
    v_sub_f32 v20, 0, v20
    v_mul_f32 v21, 0x3acccccd, v21
    v_mul_f32 v27, 0x3acccccd, v27
    v_fma_f32 v27, -v21, v21, v27
    v_max_f32 v27, 0, v27
    v_cvt_pk_bf16_f32 v14, v21, v21
    v_lshlrev_b32 v21, 16, v14
    v_cvt_pk_bf16_f32 v14, v27, v27
    v_lshlrev_b32 v27, 16, v14
    v_add_f32 v27, 0x3727c5ac, v27
    v_cvt_pk_bf16_f32 v14, v27, v27
    v_lshlrev_b32 v27, 16, v14
    v_sqrt_f32 v27, v27
    s_nop 0
    v_cvt_pk_bf16_f32 v14, v27, v27
    v_lshlrev_b32 v27, 16, v14
    v_rcp_f32 v27, v27
    v_sub_f32 v21, 0, v21
    v_mul_f32 v22, 0x3acccccd, v22
    v_mul_f32 v28, 0x3acccccd, v28
    v_fma_f32 v28, -v22, v22, v28
    v_max_f32 v28, 0, v28
    v_cvt_pk_bf16_f32 v14, v22, v22
    v_lshlrev_b32 v22, 16, v14
    v_cvt_pk_bf16_f32 v14, v28, v28
    v_lshlrev_b32 v28, 16, v14
    v_add_f32 v28, 0x3727c5ac, v28
    v_cvt_pk_bf16_f32 v14, v28, v28
    v_lshlrev_b32 v28, 16, v14
    v_sqrt_f32 v28, v28
    s_nop 0
    v_cvt_pk_bf16_f32 v14, v28, v28
    v_lshlrev_b32 v28, 16, v14
    v_rcp_f32 v28, v28
    v_sub_f32 v22, 0, v22
    s_nop 0
    v_accvgpr_read_b32 v76, a92
    v_accvgpr_read_b32 v77, a93
    v_accvgpr_read_b32 v78, a94
    v_accvgpr_read_b32 v79, a95
    s_waitcnt lgkmcnt(4)
    v_pk_fma_f32 v[76:77], v[84:85], v[22:23], v[76:77] op_sel:[0,0,0] op_sel_hi:[1,0,1]
    v_pk_fma_f32 v[78:79], v[86:87], v[22:23], v[78:79] op_sel:[0,0,0] op_sel_hi:[1,0,1]
    v_pk_mul_f32 v[76:77], v[76:77], v[28:29] op_sel:[0,0] op_sel_hi:[1,0]
    v_pk_mul_f32 v[78:79], v[78:79], v[28:29] op_sel:[0,0] op_sel_hi:[1,0]
    v_cvt_pk_bf16_f32 v13, v76, v77
    v_lshlrev_b32 v76, 16, v13
    v_and_b32 v77, 0xffff0000, v13
    v_cvt_pk_bf16_f32 v17, v78, v79
    v_lshlrev_b32 v78, 16, v17
    v_and_b32 v79, 0xffff0000, v17
    ds_write_b128 v33, v[76:79] offset:0
    v_accvgpr_read_b32 v76, a96
    v_accvgpr_read_b32 v77, a97
    v_accvgpr_read_b32 v78, a98
    v_accvgpr_read_b32 v79, a99
    s_waitcnt lgkmcnt(4)
    v_pk_fma_f32 v[76:77], v[80:81], v[22:23], v[76:77] op_sel:[0,0,0] op_sel_hi:[1,0,1]
    v_pk_fma_f32 v[78:79], v[82:83], v[22:23], v[78:79] op_sel:[0,0,0] op_sel_hi:[1,0,1]
    v_pk_mul_f32 v[76:77], v[76:77], v[28:29] op_sel:[0,0] op_sel_hi:[1,0]
    v_pk_mul_f32 v[78:79], v[78:79], v[28:29] op_sel:[0,0] op_sel_hi:[1,0]
    v_cvt_pk_bf16_f32 v13, v76, v77
    v_lshlrev_b32 v76, 16, v13
    v_and_b32 v77, 0xffff0000, v13
    v_cvt_pk_bf16_f32 v17, v78, v79
    v_lshlrev_b32 v78, 16, v17
    v_and_b32 v79, 0xffff0000, v17
    ds_write_b128 v33, v[76:79] offset:64
    s_waitcnt lgkmcnt(4)
    v_pk_fma_f32 v[152:153], v[52:53], v[18:19], v[152:153] op_sel:[0,0,0] op_sel_hi:[1,0,1]
    v_pk_fma_f32 v[154:155], v[54:55], v[18:19], v[154:155] op_sel:[0,0,0] op_sel_hi:[1,0,1]
    v_pk_mul_f32 v[152:153], v[152:153], v[24:25] op_sel:[0,0] op_sel_hi:[1,0]
    v_pk_mul_f32 v[154:155], v[154:155], v[24:25] op_sel:[0,0] op_sel_hi:[1,0]
    v_pk_fma_f32 v[156:157], v[52:53], v[18:19], v[156:157] op_sel:[0,1,0] op_sel_hi:[1,1,1]
    v_pk_fma_f32 v[158:159], v[54:55], v[18:19], v[158:159] op_sel:[0,1,0] op_sel_hi:[1,1,1]
    v_pk_mul_f32 v[156:157], v[156:157], v[24:25] op_sel:[0,1] op_sel_hi:[1,1]
    v_pk_mul_f32 v[158:159], v[158:159], v[24:25] op_sel:[0,1] op_sel_hi:[1,1]
    v_pk_fma_f32 v[160:161], v[52:53], v[20:21], v[160:161] op_sel:[0,0,0] op_sel_hi:[1,0,1]
    v_pk_fma_f32 v[162:163], v[54:55], v[20:21], v[162:163] op_sel:[0,0,0] op_sel_hi:[1,0,1]
    v_pk_mul_f32 v[160:161], v[160:161], v[26:27] op_sel:[0,0] op_sel_hi:[1,0]
    v_pk_mul_f32 v[162:163], v[162:163], v[26:27] op_sel:[0,0] op_sel_hi:[1,0]
    v_pk_fma_f32 v[164:165], v[52:53], v[20:21], v[164:165] op_sel:[0,1,0] op_sel_hi:[1,1,1]
    v_pk_fma_f32 v[166:167], v[54:55], v[20:21], v[166:167] op_sel:[0,1,0] op_sel_hi:[1,1,1]
    s_mov_b32 s48, 143360
    buffer_load_dwordx4 a[40:43], v47, s[68:71], s48 offen offset:0
    v_pk_mul_f32 v[164:165], v[164:165], v[26:27] op_sel:[0,1] op_sel_hi:[1,1]
    v_pk_mul_f32 v[166:167], v[166:167], v[26:27] op_sel:[0,1] op_sel_hi:[1,1]
    ds_read_b128 v[64:67], v12 offset:448
    s_waitcnt lgkmcnt(4)
    v_pk_fma_f32 v[200:201], v[56:57], v[18:19], v[200:201] op_sel:[0,0,0] op_sel_hi:[1,0,1]
    v_pk_fma_f32 v[202:203], v[58:59], v[18:19], v[202:203] op_sel:[0,0,0] op_sel_hi:[1,0,1]
    v_pk_mul_f32 v[200:201], v[200:201], v[24:25] op_sel:[0,0] op_sel_hi:[1,0]
    v_pk_mul_f32 v[202:203], v[202:203], v[24:25] op_sel:[0,0] op_sel_hi:[1,0]
    v_pk_fma_f32 v[204:205], v[56:57], v[18:19], v[204:205] op_sel:[0,1,0] op_sel_hi:[1,1,1]
    v_pk_fma_f32 v[206:207], v[58:59], v[18:19], v[206:207] op_sel:[0,1,0] op_sel_hi:[1,1,1]
    v_pk_mul_f32 v[204:205], v[204:205], v[24:25] op_sel:[0,1] op_sel_hi:[1,1]
    v_pk_mul_f32 v[206:207], v[206:207], v[24:25] op_sel:[0,1] op_sel_hi:[1,1]
    v_pk_fma_f32 v[208:209], v[56:57], v[20:21], v[208:209] op_sel:[0,0,0] op_sel_hi:[1,0,1]
    v_pk_fma_f32 v[210:211], v[58:59], v[20:21], v[210:211] op_sel:[0,0,0] op_sel_hi:[1,0,1]
    v_pk_mul_f32 v[208:209], v[208:209], v[26:27] op_sel:[0,0] op_sel_hi:[1,0]
    v_pk_mul_f32 v[210:211], v[210:211], v[26:27] op_sel:[0,0] op_sel_hi:[1,0]
    buffer_load_dwordx4 a[44:47], v47, s[68:71], s48 offen offset:1024
    v_pk_fma_f32 v[212:213], v[56:57], v[20:21], v[212:213] op_sel:[0,1,0] op_sel_hi:[1,1,1]
    v_pk_fma_f32 v[214:215], v[58:59], v[20:21], v[214:215] op_sel:[0,1,0] op_sel_hi:[1,1,1]
    v_pk_mul_f32 v[212:213], v[212:213], v[26:27] op_sel:[0,1] op_sel_hi:[1,1]
    v_pk_mul_f32 v[214:215], v[214:215], v[26:27] op_sel:[0,1] op_sel_hi:[1,1]
    ds_read_b128 v[52:55], v12 offset:128
    v_cvt_pk_bf16_f32 v68, v152, v153
    v_cvt_pk_bf16_f32 v69, v154, v155
    v_cvt_pk_bf16_f32 v70, v200, v201
    v_cvt_pk_bf16_f32 v71, v202, v203
    v_lshlrev_b32 v152, 16, v68
    v_and_b32 v153, s58, v68
    v_lshlrev_b32 v154, 16, v69
    v_and_b32 v155, s58, v69
    v_lshlrev_b32 v200, 16, v70
    v_and_b32 v201, s58, v70
    buffer_load_dwordx4 a[48:51], v47, s[68:71], s48 offen offset:2048
    v_lshlrev_b32 v202, 16, v71
    v_and_b32 v203, s58, v71
    v_pk_mul_f32 v[68:69], v[152:153], s[54:55]
    v_pk_mul_f32 v[70:71], v[154:155], s[54:55]
    v_exp_f32 v68, v68
    v_exp_f32 v69, v69
    v_exp_f32 v70, v70
    v_exp_f32 v71, v71
    v_pk_add_f32 v[68:69], v[68:69], s[56:57]
    v_pk_add_f32 v[70:71], v[70:71], s[56:57]
    v_rcp_f32 v68, v68
    v_rcp_f32 v69, v69
    v_rcp_f32 v70, v70
    v_rcp_f32 v71, v71
    buffer_load_dwordx4 a[52:55], v47, s[68:71], s48 offen offset:3072
    v_pk_mul_f32 v[152:153], v[152:153], v[68:69]
    v_pk_mul_f32 v[154:155], v[154:155], v[70:71]
    v_cvt_pk_bf16_f32 v72, v152, v153
    v_cvt_pk_bf16_f32 v74, v154, v155
    v_lshlrev_b32 v152, 16, v72
    v_and_b32 v153, s58, v72
    v_lshlrev_b32 v154, 16, v74
    v_and_b32 v155, s58, v74
    v_pk_mul_f32 v[152:153], v[152:153], v[200:201]
    v_pk_mul_f32 v[154:155], v[154:155], v[202:203]
    v_cvt_pk_bf16_f32 v74, v152, v153
    v_cvt_pk_bf16_f32 v75, v154, v155
    buffer_store_dwordx2 v[74:75], v35, s[40:43], 0 offen offset:0 sc1
    v_cvt_pk_bf16_f32 v76, v156, v157
    v_cvt_pk_bf16_f32 v77, v158, v159
    buffer_load_dwordx4 a[56:59], v29, s[68:71], s48 offen offset:0
    v_cvt_pk_bf16_f32 v78, v204, v205
    v_cvt_pk_bf16_f32 v79, v206, v207
    v_lshlrev_b32 v156, 16, v76
    v_and_b32 v157, s58, v76
    v_lshlrev_b32 v158, 16, v77
    v_and_b32 v159, s58, v77
    v_lshlrev_b32 v204, 16, v78
    v_and_b32 v205, s58, v78
    v_lshlrev_b32 v206, 16, v79
    v_and_b32 v207, s58, v79
    v_pk_mul_f32 v[76:77], v[156:157], s[54:55]
    v_pk_mul_f32 v[78:79], v[158:159], s[54:55]
    v_exp_f32 v76, v76
    v_exp_f32 v77, v77
    s_mov_b32 s48, 163840
    buffer_load_dwordx4 a[60:63], v47, s[68:71], s48 offen offset:0
    v_exp_f32 v78, v78
    v_exp_f32 v79, v79
    v_pk_add_f32 v[76:77], v[76:77], s[56:57]
    v_pk_add_f32 v[78:79], v[78:79], s[56:57]
    v_rcp_f32 v76, v76
    v_rcp_f32 v77, v77
    v_rcp_f32 v78, v78
    v_rcp_f32 v79, v79
    v_pk_mul_f32 v[156:157], v[156:157], v[76:77]
    v_pk_mul_f32 v[158:159], v[158:159], v[78:79]
    v_cvt_pk_bf16_f32 v80, v156, v157
    v_cvt_pk_bf16_f32 v82, v158, v159
    v_lshlrev_b32 v156, 16, v80
    v_and_b32 v157, s58, v80
    buffer_load_dwordx4 a[64:67], v47, s[68:71], s48 offen offset:1024
    v_lshlrev_b32 v158, 16, v82
    v_and_b32 v159, s58, v82
    v_pk_mul_f32 v[156:157], v[156:157], v[204:205]
    v_pk_mul_f32 v[158:159], v[158:159], v[206:207]
    v_cvt_pk_bf16_f32 v82, v156, v157
    v_cvt_pk_bf16_f32 v83, v158, v159
    buffer_store_dwordx2 v[82:83], v36, s[40:43], 0 offen offset:0 sc1
    v_cvt_pk_bf16_f32 v68, v160, v161
    v_cvt_pk_bf16_f32 v69, v162, v163
    v_cvt_pk_bf16_f32 v70, v208, v209
    v_cvt_pk_bf16_f32 v71, v210, v211
    v_lshlrev_b32 v160, 16, v68
    v_and_b32 v161, s58, v68
    v_lshlrev_b32 v162, 16, v69
    v_and_b32 v163, s58, v69
    buffer_load_dwordx4 a[68:71], v47, s[68:71], s48 offen offset:2048
    v_lshlrev_b32 v208, 16, v70
    v_and_b32 v209, s58, v70
    v_lshlrev_b32 v210, 16, v71
    v_and_b32 v211, s58, v71
    v_pk_mul_f32 v[68:69], v[160:161], s[54:55]
    v_pk_mul_f32 v[70:71], v[162:163], s[54:55]
    v_exp_f32 v68, v68
    v_exp_f32 v69, v69
    v_exp_f32 v70, v70
    v_exp_f32 v71, v71
    v_pk_add_f32 v[68:69], v[68:69], s[56:57]
    v_pk_add_f32 v[70:71], v[70:71], s[56:57]
    v_rcp_f32 v68, v68
    v_rcp_f32 v69, v69
    buffer_load_dwordx4 a[72:75], v47, s[68:71], s48 offen offset:3072
    v_rcp_f32 v70, v70
    v_rcp_f32 v71, v71
    v_pk_mul_f32 v[160:161], v[160:161], v[68:69]
    v_pk_mul_f32 v[162:163], v[162:163], v[70:71]
    v_cvt_pk_bf16_f32 v72, v160, v161
    v_cvt_pk_bf16_f32 v74, v162, v163
    v_lshlrev_b32 v160, 16, v72
    v_and_b32 v161, s58, v72
    v_lshlrev_b32 v162, 16, v74
    v_and_b32 v163, s58, v74
    v_pk_mul_f32 v[160:161], v[160:161], v[208:209]
    v_pk_mul_f32 v[162:163], v[162:163], v[210:211]
    v_cvt_pk_bf16_f32 v74, v160, v161
    v_cvt_pk_bf16_f32 v75, v162, v163
    buffer_load_dwordx4 a[76:79], v29, s[68:71], s48 offen offset:0
    buffer_store_dwordx2 v[74:75], v37, s[40:43], 0 offen offset:0 sc1
    v_cvt_pk_bf16_f32 v76, v164, v165
    v_cvt_pk_bf16_f32 v77, v166, v167
    v_cvt_pk_bf16_f32 v78, v212, v213
    v_cvt_pk_bf16_f32 v79, v214, v215
    v_lshlrev_b32 v164, 16, v76
    v_and_b32 v165, s58, v76
    v_lshlrev_b32 v166, 16, v77
    v_and_b32 v167, s58, v77
    v_lshlrev_b32 v212, 16, v78
    v_and_b32 v213, s58, v78
    v_lshlrev_b32 v214, 16, v79
    v_and_b32 v215, s58, v79
    v_pk_mul_f32 v[76:77], v[164:165], s[54:55]
    v_pk_mul_f32 v[78:79], v[166:167], s[54:55]
    s_mov_b32 s48, 184320
    buffer_load_dwordx4 a[80:83], v47, s[68:71], s48 offen offset:0
    v_exp_f32 v76, v76
    v_exp_f32 v77, v77
    v_exp_f32 v78, v78
    v_exp_f32 v79, v79
    v_pk_add_f32 v[76:77], v[76:77], s[56:57]
    v_pk_add_f32 v[78:79], v[78:79], s[56:57]
    v_rcp_f32 v76, v76
    v_rcp_f32 v77, v77
    v_rcp_f32 v78, v78
    v_rcp_f32 v79, v79
    v_pk_mul_f32 v[164:165], v[164:165], v[76:77]
    v_pk_mul_f32 v[166:167], v[166:167], v[78:79]
    v_cvt_pk_bf16_f32 v80, v164, v165
    v_cvt_pk_bf16_f32 v82, v166, v167
    buffer_load_dwordx4 a[84:87], v47, s[68:71], s48 offen offset:1024
    v_lshlrev_b32 v164, 16, v80
    v_and_b32 v165, s58, v80
    v_lshlrev_b32 v166, 16, v82
    v_and_b32 v167, s58, v82
    v_pk_mul_f32 v[164:165], v[164:165], v[212:213]
    v_pk_mul_f32 v[166:167], v[166:167], v[214:215]
    v_cvt_pk_bf16_f32 v82, v164, v165
    v_cvt_pk_bf16_f32 v83, v166, v167
    buffer_store_dwordx2 v[82:83], v38, s[40:43], 0 offen offset:0 sc1
    s_waitcnt lgkmcnt(4)
    v_pk_fma_f32 v[168:169], v[60:61], v[18:19], v[168:169] op_sel:[0,0,0] op_sel_hi:[1,0,1]
    v_pk_fma_f32 v[170:171], v[62:63], v[18:19], v[170:171] op_sel:[0,0,0] op_sel_hi:[1,0,1]
    v_pk_mul_f32 v[168:169], v[168:169], v[24:25] op_sel:[0,0] op_sel_hi:[1,0]
    v_pk_mul_f32 v[170:171], v[170:171], v[24:25] op_sel:[0,0] op_sel_hi:[1,0]
    v_pk_fma_f32 v[172:173], v[60:61], v[18:19], v[172:173] op_sel:[0,1,0] op_sel_hi:[1,1,1]
    v_pk_fma_f32 v[174:175], v[62:63], v[18:19], v[174:175] op_sel:[0,1,0] op_sel_hi:[1,1,1]
    buffer_load_dwordx4 a[88:91], v47, s[68:71], s48 offen offset:2048
    v_pk_mul_f32 v[172:173], v[172:173], v[24:25] op_sel:[0,1] op_sel_hi:[1,1]
    v_pk_mul_f32 v[174:175], v[174:175], v[24:25] op_sel:[0,1] op_sel_hi:[1,1]
    v_pk_fma_f32 v[176:177], v[60:61], v[20:21], v[176:177] op_sel:[0,0,0] op_sel_hi:[1,0,1]
    v_pk_fma_f32 v[178:179], v[62:63], v[20:21], v[178:179] op_sel:[0,0,0] op_sel_hi:[1,0,1]
    v_pk_mul_f32 v[176:177], v[176:177], v[26:27] op_sel:[0,0] op_sel_hi:[1,0]
    v_pk_mul_f32 v[178:179], v[178:179], v[26:27] op_sel:[0,0] op_sel_hi:[1,0]
    v_pk_fma_f32 v[180:181], v[60:61], v[20:21], v[180:181] op_sel:[0,1,0] op_sel_hi:[1,1,1]
    v_pk_fma_f32 v[182:183], v[62:63], v[20:21], v[182:183] op_sel:[0,1,0] op_sel_hi:[1,1,1]
    v_pk_mul_f32 v[180:181], v[180:181], v[26:27] op_sel:[0,1] op_sel_hi:[1,1]
    v_pk_mul_f32 v[182:183], v[182:183], v[26:27] op_sel:[0,1] op_sel_hi:[1,1]
    ds_read_b128 v[56:59], v12 offset:512
    s_waitcnt lgkmcnt(2)
    v_pk_fma_f32 v[216:217], v[64:65], v[18:19], v[216:217] op_sel:[0,0,0] op_sel_hi:[1,0,1]
    v_pk_fma_f32 v[218:219], v[66:67], v[18:19], v[218:219] op_sel:[0,0,0] op_sel_hi:[1,0,1]
    v_pk_mul_f32 v[216:217], v[216:217], v[24:25] op_sel:[0,0] op_sel_hi:[1,0]
    v_pk_mul_f32 v[218:219], v[218:219], v[24:25] op_sel:[0,0] op_sel_hi:[1,0]
    buffer_load_dwordx4 a[92:95], v47, s[68:71], s48 offen offset:3072
    v_pk_fma_f32 v[220:221], v[64:65], v[18:19], v[220:221] op_sel:[0,1,0] op_sel_hi:[1,1,1]
    v_pk_fma_f32 v[222:223], v[66:67], v[18:19], v[222:223] op_sel:[0,1,0] op_sel_hi:[1,1,1]
    v_pk_mul_f32 v[220:221], v[220:221], v[24:25] op_sel:[0,1] op_sel_hi:[1,1]
    v_pk_mul_f32 v[222:223], v[222:223], v[24:25] op_sel:[0,1] op_sel_hi:[1,1]
    v_pk_fma_f32 v[224:225], v[64:65], v[20:21], v[224:225] op_sel:[0,0,0] op_sel_hi:[1,0,1]
    v_pk_fma_f32 v[226:227], v[66:67], v[20:21], v[226:227] op_sel:[0,0,0] op_sel_hi:[1,0,1]
    v_pk_mul_f32 v[224:225], v[224:225], v[26:27] op_sel:[0,0] op_sel_hi:[1,0]
    v_pk_mul_f32 v[226:227], v[226:227], v[26:27] op_sel:[0,0] op_sel_hi:[1,0]
    v_pk_fma_f32 v[228:229], v[64:65], v[20:21], v[228:229] op_sel:[0,1,0] op_sel_hi:[1,1,1]
    v_pk_fma_f32 v[230:231], v[66:67], v[20:21], v[230:231] op_sel:[0,1,0] op_sel_hi:[1,1,1]
    v_pk_mul_f32 v[228:229], v[228:229], v[26:27] op_sel:[0,1] op_sel_hi:[1,1]
    v_pk_mul_f32 v[230:231], v[230:231], v[26:27] op_sel:[0,1] op_sel_hi:[1,1]
    ds_read_b128 v[60:63], v11 offset:0
    v_cvt_pk_bf16_f32 v68, v168, v169
    v_cvt_pk_bf16_f32 v69, v170, v171
    buffer_load_dwordx4 a[96:99], v29, s[68:71], s48 offen offset:0
    v_cvt_pk_bf16_f32 v70, v216, v217
    v_cvt_pk_bf16_f32 v71, v218, v219
    v_lshlrev_b32 v168, 16, v68
    v_and_b32 v169, s58, v68
    v_lshlrev_b32 v170, 16, v69
    v_and_b32 v171, s58, v69
    v_lshlrev_b32 v216, 16, v70
    v_and_b32 v217, s58, v70
    v_lshlrev_b32 v218, 16, v71
    v_and_b32 v219, s58, v71
    v_pk_mul_f32 v[68:69], v[168:169], s[54:55]
    v_pk_mul_f32 v[70:71], v[170:171], s[54:55]
    v_exp_f32 v68, v68
    v_exp_f32 v69, v69
    s_mov_b32 s48, 204800
    buffer_load_dwordx4 a[100:103], v47, s[68:71], s48 offen offset:0
    v_exp_f32 v70, v70
    v_exp_f32 v71, v71
    v_pk_add_f32 v[68:69], v[68:69], s[56:57]
    v_pk_add_f32 v[70:71], v[70:71], s[56:57]
    v_rcp_f32 v68, v68
    v_rcp_f32 v69, v69
    v_rcp_f32 v70, v70
    v_rcp_f32 v71, v71
    v_pk_mul_f32 v[168:169], v[168:169], v[68:69]
    v_pk_mul_f32 v[170:171], v[170:171], v[70:71]
    v_cvt_pk_bf16_f32 v72, v168, v169
    v_cvt_pk_bf16_f32 v74, v170, v171
    v_lshlrev_b32 v168, 16, v72
    v_and_b32 v169, s58, v72
    buffer_load_dwordx4 a[104:107], v47, s[68:71], s48 offen offset:1024
    v_lshlrev_b32 v170, 16, v74
    v_and_b32 v171, s58, v74
    v_pk_mul_f32 v[168:169], v[168:169], v[216:217]
    v_pk_mul_f32 v[170:171], v[170:171], v[218:219]
    v_cvt_pk_bf16_f32 v74, v168, v169
    v_cvt_pk_bf16_f32 v75, v170, v171
    buffer_store_dwordx2 v[74:75], v35, s[40:43], 0 offen offset:512 sc1
    v_cvt_pk_bf16_f32 v76, v172, v173
    v_cvt_pk_bf16_f32 v77, v174, v175
    v_cvt_pk_bf16_f32 v78, v220, v221
    v_cvt_pk_bf16_f32 v79, v222, v223
    v_lshlrev_b32 v172, 16, v76
    v_and_b32 v173, s58, v76
    v_lshlrev_b32 v174, 16, v77
    v_and_b32 v175, s58, v77
    buffer_load_dwordx4 a[108:111], v47, s[68:71], s48 offen offset:2048
    v_lshlrev_b32 v220, 16, v78
    v_and_b32 v221, s58, v78
    v_lshlrev_b32 v222, 16, v79
    v_and_b32 v223, s58, v79
    v_pk_mul_f32 v[76:77], v[172:173], s[54:55]
    v_pk_mul_f32 v[78:79], v[174:175], s[54:55]
    v_exp_f32 v76, v76
    v_exp_f32 v77, v77
    v_exp_f32 v78, v78
    v_exp_f32 v79, v79
    v_pk_add_f32 v[76:77], v[76:77], s[56:57]
    v_pk_add_f32 v[78:79], v[78:79], s[56:57]
    v_rcp_f32 v76, v76
    v_rcp_f32 v77, v77
    buffer_load_dwordx4 a[112:115], v47, s[68:71], s48 offen offset:3072
    v_rcp_f32 v78, v78
    v_rcp_f32 v79, v79
    v_pk_mul_f32 v[172:173], v[172:173], v[76:77]
    v_pk_mul_f32 v[174:175], v[174:175], v[78:79]
    v_cvt_pk_bf16_f32 v80, v172, v173
    v_cvt_pk_bf16_f32 v82, v174, v175
    v_lshlrev_b32 v172, 16, v80
    v_and_b32 v173, s58, v80
    v_lshlrev_b32 v174, 16, v82
    v_and_b32 v175, s58, v82
    v_pk_mul_f32 v[172:173], v[172:173], v[220:221]
    v_pk_mul_f32 v[174:175], v[174:175], v[222:223]
    v_cvt_pk_bf16_f32 v82, v172, v173
    v_cvt_pk_bf16_f32 v83, v174, v175
    buffer_load_dwordx4 a[116:119], v29, s[68:71], s48 offen offset:0
    buffer_store_dwordx2 v[82:83], v36, s[40:43], 0 offen offset:512 sc1
    v_cvt_pk_bf16_f32 v68, v176, v177
    v_cvt_pk_bf16_f32 v69, v178, v179
    v_cvt_pk_bf16_f32 v70, v224, v225
    v_cvt_pk_bf16_f32 v71, v226, v227
    v_lshlrev_b32 v176, 16, v68
    v_and_b32 v177, s58, v68
    v_lshlrev_b32 v178, 16, v69
    v_and_b32 v179, s58, v69
    v_lshlrev_b32 v224, 16, v70
    v_and_b32 v225, s58, v70
    v_lshlrev_b32 v226, 16, v71
    v_and_b32 v227, s58, v71
    v_pk_mul_f32 v[68:69], v[176:177], s[54:55]
    v_pk_mul_f32 v[70:71], v[178:179], s[54:55]
    s_mov_b32 s48, 225280
    buffer_load_dwordx4 a[120:123], v47, s[68:71], s48 offen offset:0
    v_exp_f32 v68, v68
    v_exp_f32 v69, v69
    v_exp_f32 v70, v70
    v_exp_f32 v71, v71
    v_pk_add_f32 v[68:69], v[68:69], s[56:57]
    v_pk_add_f32 v[70:71], v[70:71], s[56:57]
    v_rcp_f32 v68, v68
    v_rcp_f32 v69, v69
    v_rcp_f32 v70, v70
    v_rcp_f32 v71, v71
    v_pk_mul_f32 v[176:177], v[176:177], v[68:69]
    v_pk_mul_f32 v[178:179], v[178:179], v[70:71]
    v_cvt_pk_bf16_f32 v72, v176, v177
    v_cvt_pk_bf16_f32 v74, v178, v179
    buffer_load_dwordx4 a[124:127], v47, s[68:71], s48 offen offset:1024
    v_lshlrev_b32 v176, 16, v72
    v_and_b32 v177, s58, v72
    v_lshlrev_b32 v178, 16, v74
    v_and_b32 v179, s58, v74
    v_pk_mul_f32 v[176:177], v[176:177], v[224:225]
    v_pk_mul_f32 v[178:179], v[178:179], v[226:227]
    v_cvt_pk_bf16_f32 v74, v176, v177
    v_cvt_pk_bf16_f32 v75, v178, v179
    buffer_store_dwordx2 v[74:75], v37, s[40:43], 0 offen offset:512 sc1
    v_cvt_pk_bf16_f32 v76, v180, v181
    v_cvt_pk_bf16_f32 v77, v182, v183
    v_cvt_pk_bf16_f32 v78, v228, v229
    v_cvt_pk_bf16_f32 v79, v230, v231
    v_lshlrev_b32 v180, 16, v76
    v_and_b32 v181, s58, v76
    buffer_load_dwordx4 a[128:131], v47, s[68:71], s48 offen offset:2048
    v_lshlrev_b32 v182, 16, v77
    v_and_b32 v183, s58, v77
    v_lshlrev_b32 v228, 16, v78
    v_and_b32 v229, s58, v78
    v_lshlrev_b32 v230, 16, v79
    v_and_b32 v231, s58, v79
    v_pk_mul_f32 v[76:77], v[180:181], s[54:55]
    v_pk_mul_f32 v[78:79], v[182:183], s[54:55]
    v_exp_f32 v76, v76
    v_exp_f32 v77, v77
    v_exp_f32 v78, v78
    v_exp_f32 v79, v79
    v_pk_add_f32 v[76:77], v[76:77], s[56:57]
    v_pk_add_f32 v[78:79], v[78:79], s[56:57]
    buffer_load_dwordx4 a[132:135], v47, s[68:71], s48 offen offset:3072
    v_rcp_f32 v76, v76
    v_rcp_f32 v77, v77
    v_rcp_f32 v78, v78
    v_rcp_f32 v79, v79
    v_pk_mul_f32 v[180:181], v[180:181], v[76:77]
    v_pk_mul_f32 v[182:183], v[182:183], v[78:79]
    v_cvt_pk_bf16_f32 v80, v180, v181
    v_cvt_pk_bf16_f32 v82, v182, v183
    v_lshlrev_b32 v180, 16, v80
    v_and_b32 v181, s58, v80
    v_lshlrev_b32 v182, 16, v82
    v_and_b32 v183, s58, v82
    v_pk_mul_f32 v[180:181], v[180:181], v[228:229]
    v_pk_mul_f32 v[182:183], v[182:183], v[230:231]
    buffer_load_dwordx4 a[136:139], v29, s[68:71], s48 offen offset:0
    v_cvt_pk_bf16_f32 v82, v180, v181
    v_cvt_pk_bf16_f32 v83, v182, v183
    buffer_store_dwordx2 v[82:83], v38, s[40:43], 0 offen offset:512 sc1
    s_waitcnt lgkmcnt(2)
    v_pk_fma_f32 v[184:185], v[52:53], v[18:19], v[184:185] op_sel:[0,0,0] op_sel_hi:[1,0,1]
    v_pk_fma_f32 v[186:187], v[54:55], v[18:19], v[186:187] op_sel:[0,0,0] op_sel_hi:[1,0,1]
    v_pk_mul_f32 v[184:185], v[184:185], v[24:25] op_sel:[0,0] op_sel_hi:[1,0]
    v_pk_mul_f32 v[186:187], v[186:187], v[24:25] op_sel:[0,0] op_sel_hi:[1,0]
    v_pk_fma_f32 v[188:189], v[52:53], v[18:19], v[188:189] op_sel:[0,1,0] op_sel_hi:[1,1,1]
    v_pk_fma_f32 v[190:191], v[54:55], v[18:19], v[190:191] op_sel:[0,1,0] op_sel_hi:[1,1,1]
    v_pk_mul_f32 v[188:189], v[188:189], v[24:25] op_sel:[0,1] op_sel_hi:[1,1]
    v_pk_mul_f32 v[190:191], v[190:191], v[24:25] op_sel:[0,1] op_sel_hi:[1,1]
    v_pk_fma_f32 v[192:193], v[52:53], v[20:21], v[192:193] op_sel:[0,0,0] op_sel_hi:[1,0,1]
    v_pk_fma_f32 v[194:195], v[54:55], v[20:21], v[194:195] op_sel:[0,0,0] op_sel_hi:[1,0,1]
    v_pk_mul_f32 v[192:193], v[192:193], v[26:27] op_sel:[0,0] op_sel_hi:[1,0]
    v_pk_mul_f32 v[194:195], v[194:195], v[26:27] op_sel:[0,0] op_sel_hi:[1,0]
    s_mov_b32 s48, 245760
    buffer_load_dwordx4 a[140:143], v47, s[68:71], s48 offen offset:0
    v_pk_fma_f32 v[196:197], v[52:53], v[20:21], v[196:197] op_sel:[0,1,0] op_sel_hi:[1,1,1]
    v_pk_fma_f32 v[198:199], v[54:55], v[20:21], v[198:199] op_sel:[0,1,0] op_sel_hi:[1,1,1]
    v_pk_mul_f32 v[196:197], v[196:197], v[26:27] op_sel:[0,1] op_sel_hi:[1,1]
    v_pk_mul_f32 v[198:199], v[198:199], v[26:27] op_sel:[0,1] op_sel_hi:[1,1]
    ds_read_b128 v[64:67], v11 offset:64
    s_waitcnt lgkmcnt(2)
    v_pk_fma_f32 v[232:233], v[56:57], v[18:19], v[232:233] op_sel:[0,0,0] op_sel_hi:[1,0,1]
    v_pk_fma_f32 v[234:235], v[58:59], v[18:19], v[234:235] op_sel:[0,0,0] op_sel_hi:[1,0,1]
    v_pk_mul_f32 v[232:233], v[232:233], v[24:25] op_sel:[0,0] op_sel_hi:[1,0]
    v_pk_mul_f32 v[234:235], v[234:235], v[24:25] op_sel:[0,0] op_sel_hi:[1,0]
    v_pk_fma_f32 v[236:237], v[56:57], v[18:19], v[236:237] op_sel:[0,1,0] op_sel_hi:[1,1,1]
    v_pk_fma_f32 v[238:239], v[58:59], v[18:19], v[238:239] op_sel:[0,1,0] op_sel_hi:[1,1,1]
    v_pk_mul_f32 v[236:237], v[236:237], v[24:25] op_sel:[0,1] op_sel_hi:[1,1]
    v_pk_mul_f32 v[238:239], v[238:239], v[24:25] op_sel:[0,1] op_sel_hi:[1,1]
    v_pk_fma_f32 v[240:241], v[56:57], v[20:21], v[240:241] op_sel:[0,0,0] op_sel_hi:[1,0,1]
    v_pk_fma_f32 v[242:243], v[58:59], v[20:21], v[242:243] op_sel:[0,0,0] op_sel_hi:[1,0,1]
    buffer_load_dwordx4 a[144:147], v47, s[68:71], s48 offen offset:1024
    v_pk_mul_f32 v[240:241], v[240:241], v[26:27] op_sel:[0,0] op_sel_hi:[1,0]
    v_pk_mul_f32 v[242:243], v[242:243], v[26:27] op_sel:[0,0] op_sel_hi:[1,0]
    v_pk_fma_f32 v[244:245], v[56:57], v[20:21], v[244:245] op_sel:[0,1,0] op_sel_hi:[1,1,1]
    v_pk_fma_f32 v[246:247], v[58:59], v[20:21], v[246:247] op_sel:[0,1,0] op_sel_hi:[1,1,1]
    v_pk_mul_f32 v[244:245], v[244:245], v[26:27] op_sel:[0,1] op_sel_hi:[1,1]
    v_pk_mul_f32 v[246:247], v[246:247], v[26:27] op_sel:[0,1] op_sel_hi:[1,1]
    ds_read_b128 v[52:55], v11 offset:128
    v_cvt_pk_bf16_f32 v68, v184, v185
    v_cvt_pk_bf16_f32 v69, v186, v187
    v_cvt_pk_bf16_f32 v70, v232, v233
    v_cvt_pk_bf16_f32 v71, v234, v235
    v_lshlrev_b32 v184, 16, v68
    v_and_b32 v185, s58, v68
    v_lshlrev_b32 v186, 16, v69
    v_and_b32 v187, s58, v69
    buffer_load_dwordx4 a[148:151], v47, s[68:71], s48 offen offset:2048
    v_lshlrev_b32 v232, 16, v70
    v_and_b32 v233, s58, v70
    v_lshlrev_b32 v234, 16, v71
    v_and_b32 v235, s58, v71
    v_pk_mul_f32 v[68:69], v[184:185], s[54:55]
    v_pk_mul_f32 v[70:71], v[186:187], s[54:55]
    v_exp_f32 v68, v68
    v_exp_f32 v69, v69
    v_exp_f32 v70, v70
    v_exp_f32 v71, v71
    v_pk_add_f32 v[68:69], v[68:69], s[56:57]
    v_pk_add_f32 v[70:71], v[70:71], s[56:57]
    v_rcp_f32 v68, v68
    v_rcp_f32 v69, v69
    buffer_load_dwordx4 a[152:155], v47, s[68:71], s48 offen offset:3072
    v_rcp_f32 v70, v70
    v_rcp_f32 v71, v71
    v_pk_mul_f32 v[184:185], v[184:185], v[68:69]
    v_pk_mul_f32 v[186:187], v[186:187], v[70:71]
    v_cvt_pk_bf16_f32 v72, v184, v185
    v_cvt_pk_bf16_f32 v74, v186, v187
    v_lshlrev_b32 v184, 16, v72
    v_and_b32 v185, s58, v72
    v_lshlrev_b32 v186, 16, v74
    v_and_b32 v187, s58, v74
    v_pk_mul_f32 v[184:185], v[184:185], v[232:233]
    v_pk_mul_f32 v[186:187], v[186:187], v[234:235]
    v_cvt_pk_bf16_f32 v74, v184, v185
    v_cvt_pk_bf16_f32 v75, v186, v187
    buffer_load_dwordx4 a[156:159], v29, s[68:71], s48 offen offset:0
    buffer_store_dwordx2 v[74:75], v35, s[40:43], 0 offen offset:1024 sc1
    v_cvt_pk_bf16_f32 v76, v188, v189
    v_cvt_pk_bf16_f32 v77, v190, v191
    v_cvt_pk_bf16_f32 v78, v236, v237
    v_cvt_pk_bf16_f32 v79, v238, v239
    v_lshlrev_b32 v188, 16, v76
    v_and_b32 v189, s58, v76
    v_lshlrev_b32 v190, 16, v77
    v_and_b32 v191, s58, v77
    v_lshlrev_b32 v236, 16, v78
    v_and_b32 v237, s58, v78
    v_lshlrev_b32 v238, 16, v79
    v_and_b32 v239, s58, v79
    v_pk_mul_f32 v[76:77], v[188:189], s[54:55]
    v_pk_mul_f32 v[78:79], v[190:191], s[54:55]
    s_mov_b32 s48, 266240
    buffer_load_dwordx4 a[160:163], v47, s[68:71], s48 offen offset:0
    v_exp_f32 v76, v76
    v_exp_f32 v77, v77
    v_exp_f32 v78, v78
    v_exp_f32 v79, v79
    v_pk_add_f32 v[76:77], v[76:77], s[56:57]
    v_pk_add_f32 v[78:79], v[78:79], s[56:57]
    v_rcp_f32 v76, v76
    v_rcp_f32 v77, v77
    v_rcp_f32 v78, v78
    v_rcp_f32 v79, v79
    v_pk_mul_f32 v[188:189], v[188:189], v[76:77]
    v_pk_mul_f32 v[190:191], v[190:191], v[78:79]
    v_cvt_pk_bf16_f32 v80, v188, v189
    v_cvt_pk_bf16_f32 v82, v190, v191
    buffer_load_dwordx4 a[164:167], v47, s[68:71], s48 offen offset:1024
    v_lshlrev_b32 v188, 16, v80
    v_and_b32 v189, s58, v80
    v_lshlrev_b32 v190, 16, v82
    v_and_b32 v191, s58, v82
    v_pk_mul_f32 v[188:189], v[188:189], v[236:237]
    v_pk_mul_f32 v[190:191], v[190:191], v[238:239]
    v_cvt_pk_bf16_f32 v82, v188, v189
    v_cvt_pk_bf16_f32 v83, v190, v191
    buffer_store_dwordx2 v[82:83], v36, s[40:43], 0 offen offset:1024 sc1
    v_cvt_pk_bf16_f32 v68, v192, v193
    v_cvt_pk_bf16_f32 v69, v194, v195
    v_cvt_pk_bf16_f32 v70, v240, v241
    v_cvt_pk_bf16_f32 v71, v242, v243
    v_lshlrev_b32 v192, 16, v68
    v_and_b32 v193, s58, v68
    buffer_load_dwordx4 a[168:171], v47, s[68:71], s48 offen offset:2048
    v_lshlrev_b32 v194, 16, v69
    v_and_b32 v195, s58, v69
    v_lshlrev_b32 v240, 16, v70
    v_and_b32 v241, s58, v70
    v_lshlrev_b32 v242, 16, v71
    v_and_b32 v243, s58, v71
    v_pk_mul_f32 v[68:69], v[192:193], s[54:55]
    v_pk_mul_f32 v[70:71], v[194:195], s[54:55]
    v_exp_f32 v68, v68
    v_exp_f32 v69, v69
    v_exp_f32 v70, v70
    v_exp_f32 v71, v71
    v_pk_add_f32 v[68:69], v[68:69], s[56:57]
    v_pk_add_f32 v[70:71], v[70:71], s[56:57]
    buffer_load_dwordx4 a[172:175], v47, s[68:71], s48 offen offset:3072
    v_rcp_f32 v68, v68
    v_rcp_f32 v69, v69
    v_rcp_f32 v70, v70
    v_rcp_f32 v71, v71
    v_pk_mul_f32 v[192:193], v[192:193], v[68:69]
    v_pk_mul_f32 v[194:195], v[194:195], v[70:71]
    v_cvt_pk_bf16_f32 v72, v192, v193
    v_cvt_pk_bf16_f32 v74, v194, v195
    v_lshlrev_b32 v192, 16, v72
    v_and_b32 v193, s58, v72
    v_lshlrev_b32 v194, 16, v74
    v_and_b32 v195, s58, v74
    v_pk_mul_f32 v[192:193], v[192:193], v[240:241]
    v_pk_mul_f32 v[194:195], v[194:195], v[242:243]
    buffer_load_dwordx4 a[176:179], v29, s[68:71], s48 offen offset:0
    v_cvt_pk_bf16_f32 v74, v192, v193
    v_cvt_pk_bf16_f32 v75, v194, v195
    buffer_store_dwordx2 v[74:75], v37, s[40:43], 0 offen offset:1024 sc1
    v_cvt_pk_bf16_f32 v76, v196, v197
    v_cvt_pk_bf16_f32 v77, v198, v199
    v_cvt_pk_bf16_f32 v78, v244, v245
    v_cvt_pk_bf16_f32 v79, v246, v247
    v_lshlrev_b32 v196, 16, v76
    v_and_b32 v197, s58, v76
    v_lshlrev_b32 v198, 16, v77
    v_and_b32 v199, s58, v77
    v_lshlrev_b32 v244, 16, v78
    v_and_b32 v245, s58, v78
    v_lshlrev_b32 v246, 16, v79
    v_and_b32 v247, s58, v79
    s_mov_b32 s48, 286720
    buffer_load_dwordx4 a[180:183], v47, s[68:71], s48 offen offset:0
    v_pk_mul_f32 v[76:77], v[196:197], s[54:55]
    v_pk_mul_f32 v[78:79], v[198:199], s[54:55]
    v_exp_f32 v76, v76
    v_exp_f32 v77, v77
    v_exp_f32 v78, v78
    v_exp_f32 v79, v79
    v_pk_add_f32 v[76:77], v[76:77], s[56:57]
    v_pk_add_f32 v[78:79], v[78:79], s[56:57]
    v_rcp_f32 v76, v76
    v_rcp_f32 v77, v77
    v_rcp_f32 v78, v78
    v_rcp_f32 v79, v79
    v_pk_mul_f32 v[196:197], v[196:197], v[76:77]
    v_pk_mul_f32 v[198:199], v[198:199], v[78:79]
    buffer_load_dwordx4 a[184:187], v47, s[68:71], s48 offen offset:1024
    v_cvt_pk_bf16_f32 v80, v196, v197
    v_cvt_pk_bf16_f32 v82, v198, v199
    v_lshlrev_b32 v196, 16, v80
    v_and_b32 v197, s58, v80
    v_lshlrev_b32 v198, 16, v82
    v_and_b32 v199, s58, v82
    v_pk_mul_f32 v[196:197], v[196:197], v[244:245]
    v_pk_mul_f32 v[198:199], v[198:199], v[246:247]
    v_cvt_pk_bf16_f32 v82, v196, v197
    v_cvt_pk_bf16_f32 v83, v198, v199
    buffer_store_dwordx2 v[82:83], v38, s[40:43], 0 offen offset:1024 sc1
    s_waitcnt lgkmcnt(2)
    v_pk_fma_f32 v[88:89], v[60:61], v[18:19], v[88:89] op_sel:[0,0,0] op_sel_hi:[1,0,1]
    v_pk_fma_f32 v[90:91], v[62:63], v[18:19], v[90:91] op_sel:[0,0,0] op_sel_hi:[1,0,1]
    v_pk_mul_f32 v[88:89], v[88:89], v[24:25] op_sel:[0,0] op_sel_hi:[1,0]
    v_pk_mul_f32 v[90:91], v[90:91], v[24:25] op_sel:[0,0] op_sel_hi:[1,0]
    buffer_load_dwordx4 a[188:191], v47, s[68:71], s48 offen offset:2048
    v_pk_fma_f32 v[92:93], v[60:61], v[18:19], v[92:93] op_sel:[0,1,0] op_sel_hi:[1,1,1]
    v_pk_fma_f32 v[94:95], v[62:63], v[18:19], v[94:95] op_sel:[0,1,0] op_sel_hi:[1,1,1]
    v_pk_mul_f32 v[92:93], v[92:93], v[24:25] op_sel:[0,1] op_sel_hi:[1,1]
    v_pk_mul_f32 v[94:95], v[94:95], v[24:25] op_sel:[0,1] op_sel_hi:[1,1]
    v_pk_fma_f32 v[96:97], v[60:61], v[20:21], v[96:97] op_sel:[0,0,0] op_sel_hi:[1,0,1]
    v_pk_fma_f32 v[98:99], v[62:63], v[20:21], v[98:99] op_sel:[0,0,0] op_sel_hi:[1,0,1]
    v_pk_mul_f32 v[96:97], v[96:97], v[26:27] op_sel:[0,0] op_sel_hi:[1,0]
    v_pk_mul_f32 v[98:99], v[98:99], v[26:27] op_sel:[0,0] op_sel_hi:[1,0]
    v_pk_fma_f32 v[100:101], v[60:61], v[20:21], v[100:101] op_sel:[0,1,0] op_sel_hi:[1,1,1]
    v_pk_fma_f32 v[102:103], v[62:63], v[20:21], v[102:103] op_sel:[0,1,0] op_sel_hi:[1,1,1]
    v_pk_mul_f32 v[100:101], v[100:101], v[26:27] op_sel:[0,1] op_sel_hi:[1,1]
    v_pk_mul_f32 v[102:103], v[102:103], v[26:27] op_sel:[0,1] op_sel_hi:[1,1]
    ds_read_b128 v[56:59], v11 offset:192
    v_cvt_pk_bf16_f32 v13, v88, v89
    v_lshlrev_b32 v88, 16, v13
    buffer_load_dwordx4 a[192:195], v47, s[68:71], s48 offen offset:3072
    v_and_b32 v89, 0xffff0000, v13
    v_cvt_pk_bf16_f32 v17, v90, v91
    v_lshlrev_b32 v90, 16, v17
    v_and_b32 v91, 0xffff0000, v17
    ds_write_b128 v31, v[88:91] offset:0
    v_cvt_pk_bf16_f32 v13, v92, v93
    v_lshlrev_b32 v92, 16, v13
    v_and_b32 v93, 0xffff0000, v13
    v_cvt_pk_bf16_f32 v17, v94, v95
    v_lshlrev_b32 v94, 16, v17
    v_and_b32 v95, 0xffff0000, v17
    ds_write_b128 v31, v[92:95] offset:8448
    v_cvt_pk_bf16_f32 v13, v96, v97
    v_lshlrev_b32 v96, 16, v13
    v_and_b32 v97, 0xffff0000, v13
    v_cvt_pk_bf16_f32 v17, v98, v99
    buffer_load_dwordx4 a[196:199], v29, s[68:71], s48 offen offset:0
    v_lshlrev_b32 v98, 16, v17
    v_and_b32 v99, 0xffff0000, v17
    ds_write_b128 v32, v[96:99] offset:0
    v_cvt_pk_bf16_f32 v13, v100, v101
    v_lshlrev_b32 v100, 16, v13
    v_and_b32 v101, 0xffff0000, v13
    v_cvt_pk_bf16_f32 v17, v102, v103
    v_lshlrev_b32 v102, 16, v17
    v_and_b32 v103, 0xffff0000, v17
    ds_write_b128 v32, v[100:103] offset:8448
    s_waitcnt lgkmcnt(6)
    v_pk_fma_f32 v[104:105], v[64:65], v[18:19], v[104:105] op_sel:[0,0,0] op_sel_hi:[1,0,1]
    v_pk_fma_f32 v[106:107], v[66:67], v[18:19], v[106:107] op_sel:[0,0,0] op_sel_hi:[1,0,1]
    v_pk_mul_f32 v[104:105], v[104:105], v[24:25] op_sel:[0,0] op_sel_hi:[1,0]
    v_pk_mul_f32 v[106:107], v[106:107], v[24:25] op_sel:[0,0] op_sel_hi:[1,0]
    v_pk_fma_f32 v[108:109], v[64:65], v[18:19], v[108:109] op_sel:[0,1,0] op_sel_hi:[1,1,1]
    v_pk_fma_f32 v[110:111], v[66:67], v[18:19], v[110:111] op_sel:[0,1,0] op_sel_hi:[1,1,1]
    s_mov_b32 s48, 307200
    buffer_load_dwordx4 a[200:203], v47, s[68:71], s48 offen offset:0
    v_pk_mul_f32 v[108:109], v[108:109], v[24:25] op_sel:[0,1] op_sel_hi:[1,1]
    v_pk_mul_f32 v[110:111], v[110:111], v[24:25] op_sel:[0,1] op_sel_hi:[1,1]
    v_pk_fma_f32 v[112:113], v[64:65], v[20:21], v[112:113] op_sel:[0,0,0] op_sel_hi:[1,0,1]
    v_pk_fma_f32 v[114:115], v[66:67], v[20:21], v[114:115] op_sel:[0,0,0] op_sel_hi:[1,0,1]
    v_pk_mul_f32 v[112:113], v[112:113], v[26:27] op_sel:[0,0] op_sel_hi:[1,0]
    v_pk_mul_f32 v[114:115], v[114:115], v[26:27] op_sel:[0,0] op_sel_hi:[1,0]
    v_pk_fma_f32 v[116:117], v[64:65], v[20:21], v[116:117] op_sel:[0,1,0] op_sel_hi:[1,1,1]
    v_pk_fma_f32 v[118:119], v[66:67], v[20:21], v[118:119] op_sel:[0,1,0] op_sel_hi:[1,1,1]
    v_pk_mul_f32 v[116:117], v[116:117], v[26:27] op_sel:[0,1] op_sel_hi:[1,1]
    v_pk_mul_f32 v[118:119], v[118:119], v[26:27] op_sel:[0,1] op_sel_hi:[1,1]
    v_cvt_pk_bf16_f32 v13, v104, v105
    v_lshlrev_b32 v104, 16, v13
    v_and_b32 v105, 0xffff0000, v13
    v_cvt_pk_bf16_f32 v17, v106, v107
    buffer_load_dwordx4 a[204:207], v47, s[68:71], s48 offen offset:1024
    v_lshlrev_b32 v106, 16, v17
    v_and_b32 v107, 0xffff0000, v17
    ds_write_b128 v31, v[104:107] offset:64
    v_cvt_pk_bf16_f32 v13, v108, v109
    v_lshlrev_b32 v108, 16, v13
    v_and_b32 v109, 0xffff0000, v13
    v_cvt_pk_bf16_f32 v17, v110, v111
    v_lshlrev_b32 v110, 16, v17
    v_and_b32 v111, 0xffff0000, v17
    ds_write_b128 v31, v[108:111] offset:8512
    v_cvt_pk_bf16_f32 v13, v112, v113
    v_lshlrev_b32 v112, 16, v13
    v_and_b32 v113, 0xffff0000, v13
    v_cvt_pk_bf16_f32 v17, v114, v115
    v_lshlrev_b32 v114, 16, v17
    v_and_b32 v115, 0xffff0000, v17
    buffer_load_dwordx4 a[208:211], v47, s[68:71], s48 offen offset:2048
    ds_write_b128 v32, v[112:115] offset:64
    v_cvt_pk_bf16_f32 v13, v116, v117
    v_lshlrev_b32 v116, 16, v13
    v_and_b32 v117, 0xffff0000, v13
    v_cvt_pk_bf16_f32 v17, v118, v119
    v_lshlrev_b32 v118, 16, v17
    v_and_b32 v119, 0xffff0000, v17
    ds_write_b128 v32, v[116:119] offset:8512
    s_waitcnt lgkmcnt(9)
    v_pk_fma_f32 v[120:121], v[52:53], v[18:19], v[120:121] op_sel:[0,0,0] op_sel_hi:[1,0,1]
    v_pk_fma_f32 v[122:123], v[54:55], v[18:19], v[122:123] op_sel:[0,0,0] op_sel_hi:[1,0,1]
    v_pk_mul_f32 v[120:121], v[120:121], v[24:25] op_sel:[0,0] op_sel_hi:[1,0]
    v_pk_mul_f32 v[122:123], v[122:123], v[24:25] op_sel:[0,0] op_sel_hi:[1,0]
    v_pk_fma_f32 v[124:125], v[52:53], v[18:19], v[124:125] op_sel:[0,1,0] op_sel_hi:[1,1,1]
    v_pk_fma_f32 v[126:127], v[54:55], v[18:19], v[126:127] op_sel:[0,1,0] op_sel_hi:[1,1,1]
    v_pk_mul_f32 v[124:125], v[124:125], v[24:25] op_sel:[0,1] op_sel_hi:[1,1]
    v_pk_mul_f32 v[126:127], v[126:127], v[24:25] op_sel:[0,1] op_sel_hi:[1,1]
    buffer_load_dwordx4 a[212:215], v47, s[68:71], s48 offen offset:3072
    v_pk_fma_f32 v[128:129], v[52:53], v[20:21], v[128:129] op_sel:[0,0,0] op_sel_hi:[1,0,1]
    v_pk_fma_f32 v[130:131], v[54:55], v[20:21], v[130:131] op_sel:[0,0,0] op_sel_hi:[1,0,1]
    v_pk_mul_f32 v[128:129], v[128:129], v[26:27] op_sel:[0,0] op_sel_hi:[1,0]
    v_pk_mul_f32 v[130:131], v[130:131], v[26:27] op_sel:[0,0] op_sel_hi:[1,0]
    v_pk_fma_f32 v[132:133], v[52:53], v[20:21], v[132:133] op_sel:[0,1,0] op_sel_hi:[1,1,1]
    v_pk_fma_f32 v[134:135], v[54:55], v[20:21], v[134:135] op_sel:[0,1,0] op_sel_hi:[1,1,1]
    v_pk_mul_f32 v[132:133], v[132:133], v[26:27] op_sel:[0,1] op_sel_hi:[1,1]
    v_pk_mul_f32 v[134:135], v[134:135], v[26:27] op_sel:[0,1] op_sel_hi:[1,1]
    v_cvt_pk_bf16_f32 v13, v120, v121
    v_lshlrev_b32 v120, 16, v13
    v_and_b32 v121, 0xffff0000, v13
    v_cvt_pk_bf16_f32 v17, v122, v123
    v_lshlrev_b32 v122, 16, v17
    v_and_b32 v123, 0xffff0000, v17
    buffer_load_dwordx4 a[216:219], v29, s[68:71], s48 offen offset:0
    ds_write_b128 v31, v[120:123] offset:128
    v_cvt_pk_bf16_f32 v13, v124, v125
    v_lshlrev_b32 v124, 16, v13
    v_and_b32 v125, 0xffff0000, v13
    v_cvt_pk_bf16_f32 v17, v126, v127
    v_lshlrev_b32 v126, 16, v17
    v_and_b32 v127, 0xffff0000, v17
    ds_write_b128 v31, v[124:127] offset:8576
    v_cvt_pk_bf16_f32 v13, v128, v129
    v_lshlrev_b32 v128, 16, v13
    v_and_b32 v129, 0xffff0000, v13
    v_cvt_pk_bf16_f32 v17, v130, v131
    v_lshlrev_b32 v130, 16, v17
    v_and_b32 v131, 0xffff0000, v17
    ds_write_b128 v32, v[128:131] offset:128
    v_cvt_pk_bf16_f32 v13, v132, v133
    v_lshlrev_b32 v132, 16, v13
    s_mov_b32 s48, 327680
    buffer_load_dwordx4 a[220:223], v47, s[68:71], s48 offen offset:0
    v_and_b32 v133, 0xffff0000, v13
    v_cvt_pk_bf16_f32 v17, v134, v135
    v_lshlrev_b32 v134, 16, v17
    v_and_b32 v135, 0xffff0000, v17
    ds_write_b128 v32, v[132:135] offset:8576
    s_waitcnt lgkmcnt(12)
    v_pk_fma_f32 v[136:137], v[56:57], v[18:19], v[136:137] op_sel:[0,0,0] op_sel_hi:[1,0,1]
    v_pk_fma_f32 v[138:139], v[58:59], v[18:19], v[138:139] op_sel:[0,0,0] op_sel_hi:[1,0,1]
    v_pk_mul_f32 v[136:137], v[136:137], v[24:25] op_sel:[0,0] op_sel_hi:[1,0]
    v_pk_mul_f32 v[138:139], v[138:139], v[24:25] op_sel:[0,0] op_sel_hi:[1,0]
    v_pk_fma_f32 v[140:141], v[56:57], v[18:19], v[140:141] op_sel:[0,1,0] op_sel_hi:[1,1,1]
    v_pk_fma_f32 v[142:143], v[58:59], v[18:19], v[142:143] op_sel:[0,1,0] op_sel_hi:[1,1,1]
    v_pk_mul_f32 v[140:141], v[140:141], v[24:25] op_sel:[0,1] op_sel_hi:[1,1]
    v_pk_mul_f32 v[142:143], v[142:143], v[24:25] op_sel:[0,1] op_sel_hi:[1,1]
    v_pk_fma_f32 v[144:145], v[56:57], v[20:21], v[144:145] op_sel:[0,0,0] op_sel_hi:[1,0,1]
    v_pk_fma_f32 v[146:147], v[58:59], v[20:21], v[146:147] op_sel:[0,0,0] op_sel_hi:[1,0,1]
    buffer_load_dwordx4 a[224:227], v47, s[68:71], s48 offen offset:1024
    v_pk_mul_f32 v[144:145], v[144:145], v[26:27] op_sel:[0,0] op_sel_hi:[1,0]
    v_pk_mul_f32 v[146:147], v[146:147], v[26:27] op_sel:[0,0] op_sel_hi:[1,0]
    v_pk_fma_f32 v[148:149], v[56:57], v[20:21], v[148:149] op_sel:[0,1,0] op_sel_hi:[1,1,1]
    v_pk_fma_f32 v[150:151], v[58:59], v[20:21], v[150:151] op_sel:[0,1,0] op_sel_hi:[1,1,1]
    v_pk_mul_f32 v[148:149], v[148:149], v[26:27] op_sel:[0,1] op_sel_hi:[1,1]
    v_pk_mul_f32 v[150:151], v[150:151], v[26:27] op_sel:[0,1] op_sel_hi:[1,1]
    v_cvt_pk_bf16_f32 v13, v136, v137
    v_lshlrev_b32 v136, 16, v13
    v_and_b32 v137, 0xffff0000, v13
    v_cvt_pk_bf16_f32 v17, v138, v139
    v_lshlrev_b32 v138, 16, v17
    v_and_b32 v139, 0xffff0000, v17
    ds_write_b128 v31, v[136:139] offset:192
    v_cvt_pk_bf16_f32 v13, v140, v141
    v_lshlrev_b32 v140, 16, v13
    buffer_load_dwordx4 a[228:231], v47, s[68:71], s48 offen offset:2048
    v_and_b32 v141, 0xffff0000, v13
    v_cvt_pk_bf16_f32 v17, v142, v143
    v_lshlrev_b32 v142, 16, v17
    v_and_b32 v143, 0xffff0000, v17
    ds_write_b128 v31, v[140:143] offset:8640
    v_cvt_pk_bf16_f32 v13, v144, v145
    v_lshlrev_b32 v144, 16, v13
    v_and_b32 v145, 0xffff0000, v13
    v_cvt_pk_bf16_f32 v17, v146, v147
    v_lshlrev_b32 v146, 16, v17
    v_and_b32 v147, 0xffff0000, v17
    ds_write_b128 v32, v[144:147] offset:192
    v_cvt_pk_bf16_f32 v13, v148, v149
    v_lshlrev_b32 v148, 16, v13
    v_and_b32 v149, 0xffff0000, v13
    v_cvt_pk_bf16_f32 v17, v150, v151
    buffer_load_dwordx4 a[232:235], v47, s[68:71], s48 offen offset:3072
    v_lshlrev_b32 v150, 16, v17
    v_and_b32 v151, 0xffff0000, v17
    ds_write_b128 v32, v[148:151] offset:8640
    s_lshl_b32 s17, s80, 2
    v_add_u32 v19, 0, v3
    v_and_b32 v19, 3, v19
    v_add_u32 v20, s17, v19
    v_lshl_add_u32 v21, v3, 10, v30
    v_mul_u32_u24 v6, 49152, v20
    v_add_u32 v6, v6, v21
    v_mul_u32_u24 v10, 20480, v20
    v_add_u32 v10, v10, v21
    v_mul_u32_u24 v19, 30720, v19
    v_add_u32 v18, v19, v30
    v_add_u32 v19, 1, v3
    v_and_b32 v19, 3, v19
    buffer_load_dwordx4 a[236:239], v29, s[68:71], s48 offen offset:0
    v_add_u32 v20, s17, v19
    v_lshl_add_u32 v21, v3, 10, v30
    v_mul_u32_u24 v7, 49152, v20
    v_add_u32 v7, v7, v21
    v_mul_u32_u24 v11, 20480, v20
    v_add_u32 v11, v11, v21
    v_mul_u32_u24 v19, 30720, v19
    v_add_u32 v19, 0, v19
    v_add_u32 v15, v19, v30
    v_add_u32 v19, 2, v3
    v_and_b32 v19, 3, v19
    v_add_u32 v20, s17, v19
    v_lshl_add_u32 v21, v3, 10, v30
    v_mul_u32_u24 v8, 49152, v20
    v_add_u32 v8, v8, v21
    v_mul_u32_u24 v12, 20480, v20
    v_add_u32 v12, v12, v21
    v_mul_u32_u24 v19, 30720, v19
    v_add_u32 v19, 5120, v19
    v_add_u32 v16, v19, v30
    v_add_u32 v19, 3, v3
    v_and_b32 v19, 3, v19
    v_add_u32 v20, s17, v19
    v_lshl_add_u32 v21, v3, 10, v30
    v_mul_u32_u24 v9, 49152, v20
    v_add_u32 v9, v9, v21
    v_mul_u32_u24 v13, 20480, v20
    v_add_u32 v13, v13, v21
    v_mul_u32_u24 v19, 30720, v19
    v_add_u32 v19, 10240, v19
    v_add_u32 v17, v19, v30
    s_add_u32 s17, s17, s16
    s_lshl_b32 s17, s17, 4
    v_add_u32 v14, s17, v1
    v_mul_u32_u24 v14, 1280, v14
    v_lshl_add_u32 v14, v2, 3, v14
    s_mul_i32 s19, s81, 160
    v_add_u32 v14, s19, v14
    s_waitcnt vmcnt(13)
    s_mov_b64 exec, 1
    buffer_atomic_add v50, v48, s[64:67], 0 offen offset:0
    s_mov_b64 exec, -1
    s_waitcnt lgkmcnt(0)
    s_barrier
    ds_read_b128 v[52:55], v39 offset:320
    ds_read_b128 v[56:59], v39 offset:336
    ds_read_b128 v[60:63], v39 offset:352
    ds_read_b128 v[64:67], v39 offset:368
    ds_read_b128 v[68:71], v39 offset:384
    ds_read_b128 v[88:91], v40 offset:7392
    ds_read_b128 v[92:95], v40 offset:7408
    ds_read_b128 v[96:99], v40 offset:7424
    ds_read_b128 v[100:103], v40 offset:7440
    ds_read_b128 v[104:107], v40 offset:7456
    ds_read_b128 v[108:111], v40 offset:6336
    ds_read_b128 v[112:115], v40 offset:6352
    ds_read_b128 v[116:119], v40 offset:6368
    ds_read_b128 v[120:123], v40 offset:6384
    ds_read_b128 v[124:127], v40 offset:6400
    ds_read_b128 v[128:131], v40 offset:5280
    ds_read_b128 v[132:135], v40 offset:5296
    ds_read_b128 v[136:139], v40 offset:5312
    ds_read_b128 v[140:143], v40 offset:5328
    ds_read_b128 v[144:147], v40 offset:5344
    ds_read_b128 v[148:151], v40 offset:4224
    ds_read_b128 v[152:155], v40 offset:4240
    ds_read_b128 v[156:159], v40 offset:4256
    ds_read_b128 v[160:163], v40 offset:4272
    ds_read_b128 v[164:167], v40 offset:4288
    s_waitcnt lgkmcnt(15)
    v_pk_mul_f32 v[80:81], v[52:53], v[88:89]
    v_pk_mul_f32 v[82:83], v[54:55], v[90:91]
    v_pk_fma_f32 v[80:81], v[56:57], v[92:93], v[80:81]
    v_pk_fma_f32 v[82:83], v[58:59], v[94:95], v[82:83]
    v_pk_fma_f32 v[80:81], v[60:61], v[96:97], v[80:81]
    v_pk_fma_f32 v[82:83], v[62:63], v[98:99], v[82:83]
    v_pk_fma_f32 v[80:81], v[64:65], v[100:101], v[80:81]
    v_pk_fma_f32 v[82:83], v[66:67], v[102:103], v[82:83]
    v_pk_fma_f32 v[80:81], v[68:69], v[104:105], v[80:81]
    v_pk_fma_f32 v[82:83], v[70:71], v[106:107], v[82:83]
    v_pk_add_f32 v[80:81], v[80:81], v[82:83]
    v_add_f32 v72, v80, v81
    v_cvt_pk_bf16_f32 v80, v72, v72
    v_lshlrev_b32 v72, 16, v80
    v_mul_f32 v72, 0x3e64f92e, v72
    v_cvt_pk_bf16_f32 v80, v72, v72
    v_lshlrev_b32 v72, 16, v80
    v_cmp_le_u32 vcc, 0, v41
    v_mov_b32 v81, 0xce6e6b28
    s_nop 0
    v_cndmask_b32 v72, v81, v72, vcc
    ds_read_b128 v[88:91], v40 offset:3168
    ds_read_b128 v[92:95], v40 offset:3184
    ds_read_b128 v[96:99], v40 offset:3200
    ds_read_b128 v[100:103], v40 offset:3216
    ds_read_b128 v[104:107], v40 offset:3232
    s_waitcnt lgkmcnt(15)
    v_pk_mul_f32 v[80:81], v[52:53], v[108:109]
    v_pk_mul_f32 v[82:83], v[54:55], v[110:111]
    v_pk_fma_f32 v[80:81], v[56:57], v[112:113], v[80:81]
    v_pk_fma_f32 v[82:83], v[58:59], v[114:115], v[82:83]
    v_pk_fma_f32 v[80:81], v[60:61], v[116:117], v[80:81]
    v_pk_fma_f32 v[82:83], v[62:63], v[118:119], v[82:83]
    v_pk_fma_f32 v[80:81], v[64:65], v[120:121], v[80:81]
    v_pk_fma_f32 v[82:83], v[66:67], v[122:123], v[82:83]
    v_pk_fma_f32 v[80:81], v[68:69], v[124:125], v[80:81]
    v_pk_fma_f32 v[82:83], v[70:71], v[126:127], v[82:83]
    v_pk_add_f32 v[80:81], v[80:81], v[82:83]
    v_add_f32 v73, v80, v81
    v_cvt_pk_bf16_f32 v80, v73, v73
    v_lshlrev_b32 v73, 16, v80
    v_mul_f32 v73, 0x3e64f92e, v73
    v_cvt_pk_bf16_f32 v80, v73, v73
    v_lshlrev_b32 v73, 16, v80
    v_cmp_le_u32 vcc, 2, v41
    v_mov_b32 v81, 0xce6e6b28
    s_nop 0
    v_cndmask_b32 v73, v81, v73, vcc
    ds_read_b128 v[108:111], v40 offset:2112
    ds_read_b128 v[112:115], v40 offset:2128
    ds_read_b128 v[116:119], v40 offset:2144
    ds_read_b128 v[120:123], v40 offset:2160
    ds_read_b128 v[124:127], v40 offset:2176
    s_waitcnt lgkmcnt(15)
    v_pk_mul_f32 v[80:81], v[52:53], v[128:129]
    v_pk_mul_f32 v[82:83], v[54:55], v[130:131]
    v_pk_fma_f32 v[80:81], v[56:57], v[132:133], v[80:81]
    v_pk_fma_f32 v[82:83], v[58:59], v[134:135], v[82:83]
    v_pk_fma_f32 v[80:81], v[60:61], v[136:137], v[80:81]
    v_pk_fma_f32 v[82:83], v[62:63], v[138:139], v[82:83]
    v_pk_fma_f32 v[80:81], v[64:65], v[140:141], v[80:81]
    v_pk_fma_f32 v[82:83], v[66:67], v[142:143], v[82:83]
    v_pk_fma_f32 v[80:81], v[68:69], v[144:145], v[80:81]
    v_pk_fma_f32 v[82:83], v[70:71], v[146:147], v[82:83]
    v_pk_add_f32 v[80:81], v[80:81], v[82:83]
    v_add_f32 v74, v80, v81
    v_cvt_pk_bf16_f32 v80, v74, v74
    v_lshlrev_b32 v74, 16, v80
    v_mul_f32 v74, 0x3e64f92e, v74
    v_cvt_pk_bf16_f32 v80, v74, v74
    v_lshlrev_b32 v74, 16, v80
    v_cmp_le_u32 vcc, 4, v41
    v_mov_b32 v81, 0xce6e6b28
    s_nop 0
    v_cndmask_b32 v74, v81, v74, vcc
    buffer_load_dword v51, v49, s[64:67], 0 offen offset:0 sc1
    ds_read_b128 v[128:131], v40 offset:1056
    ds_read_b128 v[132:135], v40 offset:1072
    ds_read_b128 v[136:139], v40 offset:1088
    ds_read_b128 v[140:143], v40 offset:1104
    ds_read_b128 v[144:147], v40 offset:1120
    s_waitcnt lgkmcnt(15)
    v_pk_mul_f32 v[80:81], v[52:53], v[148:149]
    v_pk_mul_f32 v[82:83], v[54:55], v[150:151]
    v_pk_fma_f32 v[80:81], v[56:57], v[152:153], v[80:81]
    v_pk_fma_f32 v[82:83], v[58:59], v[154:155], v[82:83]
    v_pk_fma_f32 v[80:81], v[60:61], v[156:157], v[80:81]
    v_pk_fma_f32 v[82:83], v[62:63], v[158:159], v[82:83]
    v_pk_fma_f32 v[80:81], v[64:65], v[160:161], v[80:81]
    v_pk_fma_f32 v[82:83], v[66:67], v[162:163], v[82:83]
    v_pk_fma_f32 v[80:81], v[68:69], v[164:165], v[80:81]
    v_pk_fma_f32 v[82:83], v[70:71], v[166:167], v[82:83]
    v_pk_add_f32 v[80:81], v[80:81], v[82:83]
    v_add_f32 v75, v80, v81
    v_cvt_pk_bf16_f32 v80, v75, v75
    v_lshlrev_b32 v75, 16, v80
    v_mul_f32 v75, 0x3e64f92e, v75
    v_cvt_pk_bf16_f32 v80, v75, v75
    v_lshlrev_b32 v75, 16, v80
    v_cmp_le_u32 vcc, 6, v41
    v_mov_b32 v81, 0xce6e6b28
    s_nop 0
    v_cndmask_b32 v75, v81, v75, vcc
    ds_read_b128 v[148:151], v40 offset:0
    ds_read_b128 v[152:155], v40 offset:16
    ds_read_b128 v[156:159], v40 offset:32
    ds_read_b128 v[160:163], v40 offset:48
    ds_read_b128 v[164:167], v40 offset:64
    s_waitcnt lgkmcnt(15)
    v_pk_mul_f32 v[80:81], v[52:53], v[88:89]
    v_pk_mul_f32 v[82:83], v[54:55], v[90:91]
    v_pk_fma_f32 v[80:81], v[56:57], v[92:93], v[80:81]
    v_pk_fma_f32 v[82:83], v[58:59], v[94:95], v[82:83]
    v_pk_fma_f32 v[80:81], v[60:61], v[96:97], v[80:81]
    v_pk_fma_f32 v[82:83], v[62:63], v[98:99], v[82:83]
    v_pk_fma_f32 v[80:81], v[64:65], v[100:101], v[80:81]
    v_pk_fma_f32 v[82:83], v[66:67], v[102:103], v[82:83]
    v_pk_fma_f32 v[80:81], v[68:69], v[104:105], v[80:81]
    v_pk_fma_f32 v[82:83], v[70:71], v[106:107], v[82:83]
    v_pk_add_f32 v[80:81], v[80:81], v[82:83]
    v_add_f32 v76, v80, v81
    v_cvt_pk_bf16_f32 v80, v76, v76
    v_lshlrev_b32 v76, 16, v80
    v_mul_f32 v76, 0x3e64f92e, v76
    v_cvt_pk_bf16_f32 v80, v76, v76
    v_lshlrev_b32 v76, 16, v80
    v_cmp_le_u32 vcc, 8, v41
    v_mov_b32 v81, 0xce6e6b28
    s_nop 0
    v_cndmask_b32 v76, v81, v76, vcc
    ds_read_b128 v[88:91], v40 offset:7552
    ds_read_b128 v[92:95], v40 offset:7568
    ds_read_b128 v[96:99], v40 offset:7584
    ds_read_b128 v[100:103], v40 offset:7600
    ds_read_b128 v[104:107], v40 offset:7616
    s_waitcnt lgkmcnt(15)
    v_pk_mul_f32 v[80:81], v[52:53], v[108:109]
    v_pk_mul_f32 v[82:83], v[54:55], v[110:111]
    v_pk_fma_f32 v[80:81], v[56:57], v[112:113], v[80:81]
    v_pk_fma_f32 v[82:83], v[58:59], v[114:115], v[82:83]
    v_pk_fma_f32 v[80:81], v[60:61], v[116:117], v[80:81]
    v_pk_fma_f32 v[82:83], v[62:63], v[118:119], v[82:83]
    v_pk_fma_f32 v[80:81], v[64:65], v[120:121], v[80:81]
    v_pk_fma_f32 v[82:83], v[66:67], v[122:123], v[82:83]
    v_pk_fma_f32 v[80:81], v[68:69], v[124:125], v[80:81]
    v_pk_fma_f32 v[82:83], v[70:71], v[126:127], v[82:83]
    v_pk_add_f32 v[80:81], v[80:81], v[82:83]
    v_add_f32 v77, v80, v81
    v_cvt_pk_bf16_f32 v80, v77, v77
    v_lshlrev_b32 v77, 16, v80
    v_mul_f32 v77, 0x3e64f92e, v77
    v_cvt_pk_bf16_f32 v80, v77, v77
    v_lshlrev_b32 v77, 16, v80
    v_cmp_le_u32 vcc, 10, v41
    v_mov_b32 v81, 0xce6e6b28
    s_nop 0
    v_cndmask_b32 v77, v81, v77, vcc
    s_waitcnt vmcnt(0)
    v_readfirstlane_b32 s60, v51
    s_cmp_ge_u32 s60, 64
    s_cselect_b32 s75, 0, 0x7f000000
    ds_read_b128 v[108:111], v40 offset:6496
    ds_read_b128 v[112:115], v40 offset:6512
    ds_read_b128 v[116:119], v40 offset:6528
    ds_read_b128 v[120:123], v40 offset:6544
    ds_read_b128 v[124:127], v40 offset:6560
    s_waitcnt lgkmcnt(15)
    v_pk_mul_f32 v[80:81], v[52:53], v[128:129]
    v_pk_mul_f32 v[82:83], v[54:55], v[130:131]
    v_pk_fma_f32 v[80:81], v[56:57], v[132:133], v[80:81]
    v_pk_fma_f32 v[82:83], v[58:59], v[134:135], v[82:83]
    v_pk_fma_f32 v[80:81], v[60:61], v[136:137], v[80:81]
    v_pk_fma_f32 v[82:83], v[62:63], v[138:139], v[82:83]
    v_pk_fma_f32 v[80:81], v[64:65], v[140:141], v[80:81]
    v_pk_fma_f32 v[82:83], v[66:67], v[142:143], v[82:83]
    s_or_b32 s49, s75, 0
    buffer_load_dwordx4 v[168:171], v6, s[40:43], s49 offen
    v_pk_fma_f32 v[80:81], v[68:69], v[144:145], v[80:81]
    v_pk_fma_f32 v[82:83], v[70:71], v[146:147], v[82:83]
    v_pk_add_f32 v[80:81], v[80:81], v[82:83]
    v_add_f32 v78, v80, v81
    v_cvt_pk_bf16_f32 v80, v78, v78
    v_lshlrev_b32 v78, 16, v80
    v_mul_f32 v78, 0x3e64f92e, v78
    v_cvt_pk_bf16_f32 v80, v78, v78
    buffer_load_dwordx4 v[172:175], v7, s[40:43], s49 offen
    v_lshlrev_b32 v78, 16, v80
    v_cmp_le_u32 vcc, 12, v41
    v_mov_b32 v81, 0xce6e6b28
    s_nop 0
    v_cndmask_b32 v78, v81, v78, vcc
    ds_read_b128 v[128:131], v40 offset:5440
    ds_read_b128 v[132:135], v40 offset:5456
    ds_read_b128 v[136:139], v40 offset:5472
    ds_read_b128 v[140:143], v40 offset:5488
    ds_read_b128 v[144:147], v40 offset:5504
    s_waitcnt lgkmcnt(15)
    v_pk_mul_f32 v[80:81], v[52:53], v[148:149]
    v_pk_mul_f32 v[82:83], v[54:55], v[150:151]
    v_pk_fma_f32 v[80:81], v[56:57], v[152:153], v[80:81]
    v_pk_fma_f32 v[82:83], v[58:59], v[154:155], v[82:83]
    v_pk_fma_f32 v[80:81], v[60:61], v[156:157], v[80:81]
    buffer_load_dwordx4 v[176:179], v8, s[40:43], s49 offen
    v_pk_fma_f32 v[82:83], v[62:63], v[158:159], v[82:83]
    v_pk_fma_f32 v[80:81], v[64:65], v[160:161], v[80:81]
    v_pk_fma_f32 v[82:83], v[66:67], v[162:163], v[82:83]
    v_pk_fma_f32 v[80:81], v[68:69], v[164:165], v[80:81]
    v_pk_fma_f32 v[82:83], v[70:71], v[166:167], v[82:83]
    v_pk_add_f32 v[80:81], v[80:81], v[82:83]
    v_add_f32 v79, v80, v81
    v_cvt_pk_bf16_f32 v80, v79, v79
    buffer_load_dwordx4 v[180:183], v9, s[40:43], s49 offen
    v_lshlrev_b32 v79, 16, v80
    v_mul_f32 v79, 0x3e64f92e, v79
    v_cvt_pk_bf16_f32 v80, v79, v79
    v_lshlrev_b32 v79, 16, v80
    v_cmp_le_u32 vcc, 14, v41
    v_mov_b32 v81, 0xce6e6b28
    s_nop 0
    v_cndmask_b32 v79, v81, v79, vcc
    v_max3_f32 v80, v72, v73, v74
    v_max3_f32 v80, v80, v75, v76
    s_or_b32 s49, s75, 4096
    buffer_load_dwordx4 v[184:187], v6, s[40:43], s49 offen
    v_max3_f32 v80, v80, v77, v78
    v_max_f32 v80, v80, v79
    v_mov_b32 v81, 0
    v_sub_f32 v72, v72, v80
    v_mul_f32 v72, 0x3fb8aa3b, v72
    v_sub_f32 v73, v73, v80
    v_mul_f32 v73, 0x3fb8aa3b, v73
    v_sub_f32 v74, v74, v80
    buffer_load_dwordx4 v[188:191], v7, s[40:43], s49 offen
    v_mul_f32 v74, 0x3fb8aa3b, v74
    v_sub_f32 v75, v75, v80
    v_mul_f32 v75, 0x3fb8aa3b, v75
    v_sub_f32 v76, v76, v80
    v_mul_f32 v76, 0x3fb8aa3b, v76
    v_sub_f32 v77, v77, v80
    v_mul_f32 v77, 0x3fb8aa3b, v77
    v_sub_f32 v78, v78, v80
    buffer_load_dwordx4 v[192:195], v8, s[40:43], s49 offen
    v_mul_f32 v78, 0x3fb8aa3b, v78
    v_sub_f32 v79, v79, v80
    v_mul_f32 v79, 0x3fb8aa3b, v79
    v_exp_f32 v72, v72
    v_exp_f32 v73, v73
    v_exp_f32 v74, v74
    v_exp_f32 v75, v75
    v_exp_f32 v76, v76
    buffer_load_dwordx4 v[196:199], v9, s[40:43], s49 offen
    v_exp_f32 v77, v77
    v_exp_f32 v78, v78
    v_exp_f32 v79, v79
    s_nop 0
    v_add_f32 v81, v81, v72
    v_add_f32 v81, v81, v73
    v_add_f32 v81, v81, v74
    v_add_f32 v81, v81, v75
    v_add_f32 v81, v81, v76
    s_or_b32 s49, s75, 8192
    buffer_load_dwordx4 v[200:203], v6, s[40:43], s49 offen
    v_add_f32 v81, v81, v77
    v_add_f32 v81, v81, v78
    v_add_f32 v81, v81, v79
    v_rcp_f32 v81, v81
    s_nop 0
    v_mul_f32 v72, v72, v81
    v_mul_f32 v73, v73, v81
    v_mul_f32 v74, v74, v81
    v_mul_f32 v75, v75, v81
    buffer_load_dwordx4 v[204:207], v7, s[40:43], s49 offen
    v_mul_f32 v76, v76, v81
    v_mul_f32 v77, v77, v81
    v_mul_f32 v78, v78, v81
    v_mul_f32 v79, v79, v81
    v_cvt_pk_bf16_f32 v80, v72, v73
    v_lshlrev_b32 v72, 16, v80
    v_and_b32 v73, 0xffff0000, v80
    v_cvt_pk_bf16_f32 v80, v74, v75
    buffer_load_dwordx4 v[208:211], v8, s[40:43], s49 offen
    v_lshlrev_b32 v74, 16, v80
    v_and_b32 v75, 0xffff0000, v80
    v_cvt_pk_bf16_f32 v80, v76, v77
    v_lshlrev_b32 v76, 16, v80
    v_and_b32 v77, 0xffff0000, v80
    v_cvt_pk_bf16_f32 v80, v78, v79
    v_lshlrev_b32 v78, 16, v80
    v_and_b32 v79, 0xffff0000, v80
    buffer_load_dwordx4 v[212:215], v9, s[40:43], s49 offen
    ds_read_b128 v[148:151], v40 offset:4384
    ds_read_b128 v[152:155], v40 offset:4400
    ds_read_b128 v[156:159], v40 offset:4416
    ds_read_b128 v[160:163], v40 offset:4432
    ds_read_b128 v[164:167], v40 offset:4448
    s_waitcnt lgkmcnt(15)
    v_pk_mul_f32 v[52:53], v[72:73], v[88:89] op_sel:[0,0] op_sel_hi:[0,1]
    v_pk_mul_f32 v[54:55], v[72:73], v[90:91] op_sel:[0,0] op_sel_hi:[0,1]
    v_pk_mul_f32 v[56:57], v[72:73], v[92:93] op_sel:[0,0] op_sel_hi:[0,1]
    v_pk_mul_f32 v[58:59], v[72:73], v[94:95] op_sel:[0,0] op_sel_hi:[0,1]
    v_pk_mul_f32 v[60:61], v[72:73], v[96:97] op_sel:[0,0] op_sel_hi:[0,1]
    v_pk_mul_f32 v[62:63], v[72:73], v[98:99] op_sel:[0,0] op_sel_hi:[0,1]
    v_pk_mul_f32 v[64:65], v[72:73], v[100:101] op_sel:[0,0] op_sel_hi:[0,1]
    v_pk_mul_f32 v[66:67], v[72:73], v[102:103] op_sel:[0,0] op_sel_hi:[0,1]
    s_or_b32 s49, s75, 12288
    buffer_load_dwordx4 v[216:219], v6, s[40:43], s49 offen
    v_pk_mul_f32 v[68:69], v[72:73], v[104:105] op_sel:[0,0] op_sel_hi:[0,1]
    v_pk_mul_f32 v[70:71], v[72:73], v[106:107] op_sel:[0,0] op_sel_hi:[0,1]
    ds_read_b128 v[88:91], v40 offset:3328
    ds_read_b128 v[92:95], v40 offset:3344
    ds_read_b128 v[96:99], v40 offset:3360
    ds_read_b128 v[100:103], v40 offset:3376
    ds_read_b128 v[104:107], v40 offset:3392
    s_waitcnt lgkmcnt(15)
    v_pk_fma_f32 v[52:53], v[72:73], v[108:109], v[52:53] op_sel:[1,0,0] op_sel_hi:[1,1,1]
    v_pk_fma_f32 v[54:55], v[72:73], v[110:111], v[54:55] op_sel:[1,0,0] op_sel_hi:[1,1,1]
    v_pk_fma_f32 v[56:57], v[72:73], v[112:113], v[56:57] op_sel:[1,0,0] op_sel_hi:[1,1,1]
    v_pk_fma_f32 v[58:59], v[72:73], v[114:115], v[58:59] op_sel:[1,0,0] op_sel_hi:[1,1,1]
    v_pk_fma_f32 v[60:61], v[72:73], v[116:117], v[60:61] op_sel:[1,0,0] op_sel_hi:[1,1,1]
    v_pk_fma_f32 v[62:63], v[72:73], v[118:119], v[62:63] op_sel:[1,0,0] op_sel_hi:[1,1,1]
    buffer_load_dwordx4 v[220:223], v7, s[40:43], s49 offen
    v_pk_fma_f32 v[64:65], v[72:73], v[120:121], v[64:65] op_sel:[1,0,0] op_sel_hi:[1,1,1]
    v_pk_fma_f32 v[66:67], v[72:73], v[122:123], v[66:67] op_sel:[1,0,0] op_sel_hi:[1,1,1]
    v_pk_fma_f32 v[68:69], v[72:73], v[124:125], v[68:69] op_sel:[1,0,0] op_sel_hi:[1,1,1]
    v_pk_fma_f32 v[70:71], v[72:73], v[126:127], v[70:71] op_sel:[1,0,0] op_sel_hi:[1,1,1]
    ds_read_b128 v[108:111], v40 offset:2272
    ds_read_b128 v[112:115], v40 offset:2288
    ds_read_b128 v[116:119], v40 offset:2304
    ds_read_b128 v[120:123], v40 offset:2320
    ds_read_b128 v[124:127], v40 offset:2336
    s_waitcnt lgkmcnt(15)
    v_pk_fma_f32 v[52:53], v[74:75], v[128:129], v[52:53] op_sel:[0,0,0] op_sel_hi:[0,1,1]
    v_pk_fma_f32 v[54:55], v[74:75], v[130:131], v[54:55] op_sel:[0,0,0] op_sel_hi:[0,1,1]
    v_pk_fma_f32 v[56:57], v[74:75], v[132:133], v[56:57] op_sel:[0,0,0] op_sel_hi:[0,1,1]
    v_pk_fma_f32 v[58:59], v[74:75], v[134:135], v[58:59] op_sel:[0,0,0] op_sel_hi:[0,1,1]
    buffer_load_dwordx4 v[224:227], v8, s[40:43], s49 offen
    v_pk_fma_f32 v[60:61], v[74:75], v[136:137], v[60:61] op_sel:[0,0,0] op_sel_hi:[0,1,1]
    v_pk_fma_f32 v[62:63], v[74:75], v[138:139], v[62:63] op_sel:[0,0,0] op_sel_hi:[0,1,1]
    v_pk_fma_f32 v[64:65], v[74:75], v[140:141], v[64:65] op_sel:[0,0,0] op_sel_hi:[0,1,1]
    v_pk_fma_f32 v[66:67], v[74:75], v[142:143], v[66:67] op_sel:[0,0,0] op_sel_hi:[0,1,1]
    v_pk_fma_f32 v[68:69], v[74:75], v[144:145], v[68:69] op_sel:[0,0,0] op_sel_hi:[0,1,1]
    v_pk_fma_f32 v[70:71], v[74:75], v[146:147], v[70:71] op_sel:[0,0,0] op_sel_hi:[0,1,1]
    ds_read_b128 v[128:131], v40 offset:1216
    ds_read_b128 v[132:135], v40 offset:1232
    ds_read_b128 v[136:139], v40 offset:1248
    ds_read_b128 v[140:143], v40 offset:1264
    ds_read_b128 v[144:147], v40 offset:1280
    s_waitcnt lgkmcnt(15)
    v_pk_fma_f32 v[52:53], v[74:75], v[148:149], v[52:53] op_sel:[1,0,0] op_sel_hi:[1,1,1]
    v_pk_fma_f32 v[54:55], v[74:75], v[150:151], v[54:55] op_sel:[1,0,0] op_sel_hi:[1,1,1]
    buffer_load_dwordx4 v[228:231], v9, s[40:43], s49 offen
    v_pk_fma_f32 v[56:57], v[74:75], v[152:153], v[56:57] op_sel:[1,0,0] op_sel_hi:[1,1,1]
    v_pk_fma_f32 v[58:59], v[74:75], v[154:155], v[58:59] op_sel:[1,0,0] op_sel_hi:[1,1,1]
    v_pk_fma_f32 v[60:61], v[74:75], v[156:157], v[60:61] op_sel:[1,0,0] op_sel_hi:[1,1,1]
    v_pk_fma_f32 v[62:63], v[74:75], v[158:159], v[62:63] op_sel:[1,0,0] op_sel_hi:[1,1,1]
    v_pk_fma_f32 v[64:65], v[74:75], v[160:161], v[64:65] op_sel:[1,0,0] op_sel_hi:[1,1,1]
    v_pk_fma_f32 v[66:67], v[74:75], v[162:163], v[66:67] op_sel:[1,0,0] op_sel_hi:[1,1,1]
    v_pk_fma_f32 v[68:69], v[74:75], v[164:165], v[68:69] op_sel:[1,0,0] op_sel_hi:[1,1,1]
    v_pk_fma_f32 v[70:71], v[74:75], v[166:167], v[70:71] op_sel:[1,0,0] op_sel_hi:[1,1,1]
    s_or_b32 s49, s75, 16384
    buffer_load_dwordx4 v[232:235], v6, s[40:43], s49 offen
    ds_read_b128 v[148:151], v40 offset:160
    ds_read_b128 v[152:155], v40 offset:176
    ds_read_b128 v[156:159], v40 offset:192
    ds_read_b128 v[160:163], v40 offset:208
    ds_read_b128 v[164:167], v40 offset:224
    s_waitcnt lgkmcnt(15)
    v_pk_fma_f32 v[52:53], v[76:77], v[88:89], v[52:53] op_sel:[0,0,0] op_sel_hi:[0,1,1]
    v_pk_fma_f32 v[54:55], v[76:77], v[90:91], v[54:55] op_sel:[0,0,0] op_sel_hi:[0,1,1]
    v_pk_fma_f32 v[56:57], v[76:77], v[92:93], v[56:57] op_sel:[0,0,0] op_sel_hi:[0,1,1]
    v_pk_fma_f32 v[58:59], v[76:77], v[94:95], v[58:59] op_sel:[0,0,0] op_sel_hi:[0,1,1]
    v_pk_fma_f32 v[60:61], v[76:77], v[96:97], v[60:61] op_sel:[0,0,0] op_sel_hi:[0,1,1]
    v_pk_fma_f32 v[62:63], v[76:77], v[98:99], v[62:63] op_sel:[0,0,0] op_sel_hi:[0,1,1]
    v_pk_fma_f32 v[64:65], v[76:77], v[100:101], v[64:65] op_sel:[0,0,0] op_sel_hi:[0,1,1]
    v_pk_fma_f32 v[66:67], v[76:77], v[102:103], v[66:67] op_sel:[0,0,0] op_sel_hi:[0,1,1]
    buffer_load_dwordx4 v[236:239], v7, s[40:43], s49 offen
    v_pk_fma_f32 v[68:69], v[76:77], v[104:105], v[68:69] op_sel:[0,0,0] op_sel_hi:[0,1,1]
    v_pk_fma_f32 v[70:71], v[76:77], v[106:107], v[70:71] op_sel:[0,0,0] op_sel_hi:[0,1,1]
    s_waitcnt lgkmcnt(10)
    v_pk_fma_f32 v[52:53], v[76:77], v[108:109], v[52:53] op_sel:[1,0,0] op_sel_hi:[1,1,1]
    v_pk_fma_f32 v[54:55], v[76:77], v[110:111], v[54:55] op_sel:[1,0,0] op_sel_hi:[1,1,1]
    v_pk_fma_f32 v[56:57], v[76:77], v[112:113], v[56:57] op_sel:[1,0,0] op_sel_hi:[1,1,1]
    v_pk_fma_f32 v[58:59], v[76:77], v[114:115], v[58:59] op_sel:[1,0,0] op_sel_hi:[1,1,1]
    v_pk_fma_f32 v[60:61], v[76:77], v[116:117], v[60:61] op_sel:[1,0,0] op_sel_hi:[1,1,1]
    v_pk_fma_f32 v[62:63], v[76:77], v[118:119], v[62:63] op_sel:[1,0,0] op_sel_hi:[1,1,1]
    buffer_load_dwordx4 v[240:243], v8, s[40:43], s49 offen
    v_pk_fma_f32 v[64:65], v[76:77], v[120:121], v[64:65] op_sel:[1,0,0] op_sel_hi:[1,1,1]
    v_pk_fma_f32 v[66:67], v[76:77], v[122:123], v[66:67] op_sel:[1,0,0] op_sel_hi:[1,1,1]
    v_pk_fma_f32 v[68:69], v[76:77], v[124:125], v[68:69] op_sel:[1,0,0] op_sel_hi:[1,1,1]
    v_pk_fma_f32 v[70:71], v[76:77], v[126:127], v[70:71] op_sel:[1,0,0] op_sel_hi:[1,1,1]
    s_waitcnt lgkmcnt(5)
    v_pk_fma_f32 v[52:53], v[78:79], v[128:129], v[52:53] op_sel:[0,0,0] op_sel_hi:[0,1,1]
    v_pk_fma_f32 v[54:55], v[78:79], v[130:131], v[54:55] op_sel:[0,0,0] op_sel_hi:[0,1,1]
    v_pk_fma_f32 v[56:57], v[78:79], v[132:133], v[56:57] op_sel:[0,0,0] op_sel_hi:[0,1,1]
    v_pk_fma_f32 v[58:59], v[78:79], v[134:135], v[58:59] op_sel:[0,0,0] op_sel_hi:[0,1,1]
    buffer_load_dwordx4 v[244:247], v9, s[40:43], s49 offen
    v_pk_fma_f32 v[60:61], v[78:79], v[136:137], v[60:61] op_sel:[0,0,0] op_sel_hi:[0,1,1]
    v_pk_fma_f32 v[62:63], v[78:79], v[138:139], v[62:63] op_sel:[0,0,0] op_sel_hi:[0,1,1]
    v_pk_fma_f32 v[64:65], v[78:79], v[140:141], v[64:65] op_sel:[0,0,0] op_sel_hi:[0,1,1]
    v_pk_fma_f32 v[66:67], v[78:79], v[142:143], v[66:67] op_sel:[0,0,0] op_sel_hi:[0,1,1]
    v_pk_fma_f32 v[68:69], v[78:79], v[144:145], v[68:69] op_sel:[0,0,0] op_sel_hi:[0,1,1]
    v_pk_fma_f32 v[70:71], v[78:79], v[146:147], v[70:71] op_sel:[0,0,0] op_sel_hi:[0,1,1]
    s_waitcnt lgkmcnt(0)
    s_barrier
    v_pk_fma_f32 v[52:53], v[78:79], v[148:149], v[52:53] op_sel:[1,0,0] op_sel_hi:[1,1,1]
    v_pk_fma_f32 v[54:55], v[78:79], v[150:151], v[54:55] op_sel:[1,0,0] op_sel_hi:[1,1,1]
    v_pk_fma_f32 v[56:57], v[78:79], v[152:153], v[56:57] op_sel:[1,0,0] op_sel_hi:[1,1,1]
    v_pk_fma_f32 v[58:59], v[78:79], v[154:155], v[58:59] op_sel:[1,0,0] op_sel_hi:[1,1,1]
    v_pk_fma_f32 v[60:61], v[78:79], v[156:157], v[60:61] op_sel:[1,0,0] op_sel_hi:[1,1,1]
    v_pk_fma_f32 v[62:63], v[78:79], v[158:159], v[62:63] op_sel:[1,0,0] op_sel_hi:[1,1,1]
    v_pk_fma_f32 v[64:65], v[78:79], v[160:161], v[64:65] op_sel:[1,0,0] op_sel_hi:[1,1,1]
    v_pk_fma_f32 v[66:67], v[78:79], v[162:163], v[66:67] op_sel:[1,0,0] op_sel_hi:[1,1,1]
    v_pk_fma_f32 v[68:69], v[78:79], v[164:165], v[68:69] op_sel:[1,0,0] op_sel_hi:[1,1,1]
    v_pk_fma_f32 v[70:71], v[78:79], v[166:167], v[70:71] op_sel:[1,0,0] op_sel_hi:[1,1,1]
    v_cvt_pk_bf16_f32 v72, v52, v53
    v_cvt_pk_bf16_f32 v73, v54, v55
    v_cvt_pk_bf16_f32 v74, v56, v57
    v_cvt_pk_bf16_f32 v75, v58, v59
    v_cvt_pk_bf16_f32 v76, v60, v61
    v_cvt_pk_bf16_f32 v77, v62, v63
    v_cvt_pk_bf16_f32 v78, v64, v65
    v_cvt_pk_bf16_f32 v79, v66, v67
    v_cvt_pk_bf16_f32 v80, v68, v69
    v_cvt_pk_bf16_f32 v81, v70, v71
    buffer_store_dwordx2 v[72:73], v42, s[36:39], 0 offen sc1
    buffer_store_dwordx2 v[74:75], v43, s[36:39], 0 offen sc1
    buffer_store_dwordx2 v[76:77], v44, s[36:39], 0 offen sc1
    buffer_store_dwordx2 v[78:79], v45, s[36:39], 0 offen sc1
    buffer_store_dwordx2 v[80:81], v46, s[36:39], 0 offen sc1
    s_cmp_eq_u32 s75, 0
    s_cbranch_scc1 k1_hf
    s_waitcnt vmcnt(0)
    s_mov_b64 exec, 1
    buffer_atomic_add v50, v48, s[64:67], 0 offen offset:2048
    s_mov_b64 exec, -1
    s_mov_b32 s61, 0
k1_h_s:
    buffer_load_dword v51, v49, s[64:67], 0 offen offset:0 sc1
    s_waitcnt vmcnt(0)
    v_readfirstlane_b32 s60, v51
    s_add_u32 s61, s61, 1
    s_cmp_ge_u32 s60, 64
    s_cbranch_scc1 k1_h_e
    s_cmp_lt_u32 s61, 50000
    s_cbranch_scc1 k1_h_s
k1_h_e:
    s_mov_b32 s49, 0
    buffer_load_dwordx4 v[168:171], v6, s[40:43], s49 offen
    buffer_load_dwordx4 v[172:175], v7, s[40:43], s49 offen
    buffer_load_dwordx4 v[176:179], v8, s[40:43], s49 offen
    buffer_load_dwordx4 v[180:183], v9, s[40:43], s49 offen
    s_mov_b32 s49, 4096
    buffer_load_dwordx4 v[184:187], v6, s[40:43], s49 offen
    buffer_load_dwordx4 v[188:191], v7, s[40:43], s49 offen
    buffer_load_dwordx4 v[192:195], v8, s[40:43], s49 offen
    buffer_load_dwordx4 v[196:199], v9, s[40:43], s49 offen
    s_mov_b32 s49, 8192
    buffer_load_dwordx4 v[200:203], v6, s[40:43], s49 offen
    buffer_load_dwordx4 v[204:207], v7, s[40:43], s49 offen
    buffer_load_dwordx4 v[208:211], v8, s[40:43], s49 offen
    buffer_load_dwordx4 v[212:215], v9, s[40:43], s49 offen
    s_mov_b32 s49, 12288
    buffer_load_dwordx4 v[216:219], v6, s[40:43], s49 offen
    buffer_load_dwordx4 v[220:223], v7, s[40:43], s49 offen
    buffer_load_dwordx4 v[224:227], v8, s[40:43], s49 offen
    buffer_load_dwordx4 v[228:231], v9, s[40:43], s49 offen
    s_mov_b32 s49, 16384
    buffer_load_dwordx4 v[232:235], v6, s[40:43], s49 offen
    buffer_load_dwordx4 v[236:239], v7, s[40:43], s49 offen
    buffer_load_dwordx4 v[240:243], v8, s[40:43], s49 offen
    buffer_load_dwordx4 v[244:247], v9, s[40:43], s49 offen
    s_waitcnt vmcnt(16)
    s_branch k1_hg
k1_hf:
    s_waitcnt vmcnt(21)
k1_hg:
    v_mfma_f32_16x16x32_bf16 v[88:91], a[0:3], v[168:171], 0
    v_mfma_f32_16x16x32_bf16 v[92:95], a[4:7], v[168:171], 0
    s_mov_b32 s49, 20480
    buffer_load_dwordx4 v[56:59], v6, s[40:43], s49 offen
    v_mfma_f32_16x16x32_bf16 v[96:99], a[8:11], v[168:171], 0
    v_mfma_f32_16x16x32_bf16 v[100:103], a[12:15], v[168:171], 0
    buffer_load_dwordx4 v[60:63], v7, s[40:43], s49 offen
    v_mfma_f32_16x16x32_bf16 v[104:107], a[16:19], v[168:171], 0
    v_mfma_f32_16x16x32_bf16 v[108:111], a[0:3], v[172:175], 0
    buffer_load_dwordx4 v[64:67], v8, s[40:43], s49 offen
    v_mfma_f32_16x16x32_bf16 v[112:115], a[4:7], v[172:175], 0
    v_mfma_f32_16x16x32_bf16 v[116:119], a[8:11], v[172:175], 0
    buffer_load_dwordx4 v[68:71], v9, s[40:43], s49 offen
    v_mfma_f32_16x16x32_bf16 v[120:123], a[12:15], v[172:175], 0
    v_mfma_f32_16x16x32_bf16 v[124:127], a[16:19], v[172:175], 0
    s_mov_b32 s49, 24576
    buffer_load_dwordx4 v[72:75], v6, s[40:43], s49 offen
    v_mfma_f32_16x16x32_bf16 v[128:131], a[0:3], v[176:179], 0
    v_mfma_f32_16x16x32_bf16 v[132:135], a[4:7], v[176:179], 0
    buffer_load_dwordx4 v[76:79], v7, s[40:43], s49 offen
    v_mfma_f32_16x16x32_bf16 v[136:139], a[8:11], v[176:179], 0
    v_mfma_f32_16x16x32_bf16 v[140:143], a[12:15], v[176:179], 0
    buffer_load_dwordx4 v[80:83], v8, s[40:43], s49 offen
    v_mfma_f32_16x16x32_bf16 v[144:147], a[16:19], v[176:179], 0
    v_mfma_f32_16x16x32_bf16 v[148:151], a[0:3], v[180:183], 0
    buffer_load_dwordx4 v[84:87], v9, s[40:43], s49 offen
    v_mfma_f32_16x16x32_bf16 v[152:155], a[4:7], v[180:183], 0
    v_mfma_f32_16x16x32_bf16 v[156:159], a[8:11], v[180:183], 0
    v_mfma_f32_16x16x32_bf16 v[160:163], a[12:15], v[180:183], 0
    v_mfma_f32_16x16x32_bf16 v[164:167], a[16:19], v[180:183], 0
    s_waitcnt vmcnt(20)
    v_mfma_f32_16x16x32_bf16 v[88:91], a[20:23], v[184:187], v[88:91]
    v_mfma_f32_16x16x32_bf16 v[92:95], a[24:27], v[184:187], v[92:95]
    s_mov_b32 s49, 28672
    buffer_load_dwordx4 v[168:171], v6, s[40:43], s49 offen
    v_mfma_f32_16x16x32_bf16 v[96:99], a[28:31], v[184:187], v[96:99]
    v_mfma_f32_16x16x32_bf16 v[100:103], a[32:35], v[184:187], v[100:103]
    buffer_load_dwordx4 v[172:175], v7, s[40:43], s49 offen
    v_mfma_f32_16x16x32_bf16 v[104:107], a[36:39], v[184:187], v[104:107]
    v_mfma_f32_16x16x32_bf16 v[108:111], a[20:23], v[188:191], v[108:111]
    buffer_load_dwordx4 v[176:179], v8, s[40:43], s49 offen
    v_mfma_f32_16x16x32_bf16 v[112:115], a[24:27], v[188:191], v[112:115]
    v_mfma_f32_16x16x32_bf16 v[116:119], a[28:31], v[188:191], v[116:119]
    buffer_load_dwordx4 v[180:183], v9, s[40:43], s49 offen
    v_mfma_f32_16x16x32_bf16 v[120:123], a[32:35], v[188:191], v[120:123]
    v_mfma_f32_16x16x32_bf16 v[124:127], a[36:39], v[188:191], v[124:127]
    s_mov_b32 s48, 0
    buffer_load_dwordx4 a[0:3], v47, s[68:71], s48 offen offset:0
    v_mfma_f32_16x16x32_bf16 v[128:131], a[20:23], v[192:195], v[128:131]
    v_mfma_f32_16x16x32_bf16 v[132:135], a[24:27], v[192:195], v[132:135]
    buffer_load_dwordx4 a[4:7], v47, s[68:71], s48 offen offset:1024
    v_mfma_f32_16x16x32_bf16 v[136:139], a[28:31], v[192:195], v[136:139]
    v_mfma_f32_16x16x32_bf16 v[140:143], a[32:35], v[192:195], v[140:143]
    buffer_load_dwordx4 a[8:11], v47, s[68:71], s48 offen offset:2048
    v_mfma_f32_16x16x32_bf16 v[144:147], a[36:39], v[192:195], v[144:147]
    v_mfma_f32_16x16x32_bf16 v[148:151], a[20:23], v[196:199], v[148:151]
    v_mfma_f32_16x16x32_bf16 v[152:155], a[24:27], v[196:199], v[152:155]
    v_mfma_f32_16x16x32_bf16 v[156:159], a[28:31], v[196:199], v[156:159]
    v_mfma_f32_16x16x32_bf16 v[160:163], a[32:35], v[196:199], v[160:163]
    v_mfma_f32_16x16x32_bf16 v[164:167], a[36:39], v[196:199], v[164:167]
    s_waitcnt vmcnt(23)
    v_mfma_f32_16x16x32_bf16 v[88:91], a[40:43], v[200:203], v[88:91]
    v_mfma_f32_16x16x32_bf16 v[92:95], a[44:47], v[200:203], v[92:95]
    s_mov_b32 s49, 32768
    buffer_load_dwordx4 v[184:187], v6, s[40:43], s49 offen
    v_mfma_f32_16x16x32_bf16 v[96:99], a[48:51], v[200:203], v[96:99]
    v_mfma_f32_16x16x32_bf16 v[100:103], a[52:55], v[200:203], v[100:103]
    buffer_load_dwordx4 v[188:191], v7, s[40:43], s49 offen
    v_mfma_f32_16x16x32_bf16 v[104:107], a[56:59], v[200:203], v[104:107]
    v_mfma_f32_16x16x32_bf16 v[108:111], a[40:43], v[204:207], v[108:111]
    buffer_load_dwordx4 v[192:195], v8, s[40:43], s49 offen
    v_mfma_f32_16x16x32_bf16 v[112:115], a[44:47], v[204:207], v[112:115]
    v_mfma_f32_16x16x32_bf16 v[116:119], a[48:51], v[204:207], v[116:119]
    buffer_load_dwordx4 v[196:199], v9, s[40:43], s49 offen
    v_mfma_f32_16x16x32_bf16 v[120:123], a[52:55], v[204:207], v[120:123]
    v_mfma_f32_16x16x32_bf16 v[124:127], a[56:59], v[204:207], v[124:127]
    buffer_load_dwordx4 a[12:15], v47, s[68:71], s48 offen offset:3072
    v_mfma_f32_16x16x32_bf16 v[128:131], a[40:43], v[208:211], v[128:131]
    v_mfma_f32_16x16x32_bf16 v[132:135], a[44:47], v[208:211], v[132:135]
    buffer_load_dwordx4 a[16:19], v29, s[68:71], s48 offen offset:0
    v_mfma_f32_16x16x32_bf16 v[136:139], a[48:51], v[208:211], v[136:139]
    v_mfma_f32_16x16x32_bf16 v[140:143], a[52:55], v[208:211], v[140:143]
    v_mfma_f32_16x16x32_bf16 v[144:147], a[56:59], v[208:211], v[144:147]
    v_mfma_f32_16x16x32_bf16 v[148:151], a[40:43], v[212:215], v[148:151]
    v_mfma_f32_16x16x32_bf16 v[152:155], a[44:47], v[212:215], v[152:155]
    v_mfma_f32_16x16x32_bf16 v[156:159], a[48:51], v[212:215], v[156:159]
    v_mfma_f32_16x16x32_bf16 v[160:163], a[52:55], v[212:215], v[160:163]
    v_mfma_f32_16x16x32_bf16 v[164:167], a[56:59], v[212:215], v[164:167]
    s_waitcnt vmcnt(25)
    v_mfma_f32_16x16x32_bf16 v[88:91], a[60:63], v[216:219], v[88:91]
    v_mfma_f32_16x16x32_bf16 v[92:95], a[64:67], v[216:219], v[92:95]
    s_mov_b32 s49, 36864
    buffer_load_dwordx4 v[200:203], v6, s[40:43], s49 offen
    v_mfma_f32_16x16x32_bf16 v[96:99], a[68:71], v[216:219], v[96:99]
    v_mfma_f32_16x16x32_bf16 v[100:103], a[72:75], v[216:219], v[100:103]
    buffer_load_dwordx4 v[204:207], v7, s[40:43], s49 offen
    v_mfma_f32_16x16x32_bf16 v[104:107], a[76:79], v[216:219], v[104:107]
    v_mfma_f32_16x16x32_bf16 v[108:111], a[60:63], v[220:223], v[108:111]
    buffer_load_dwordx4 v[208:211], v8, s[40:43], s49 offen
    v_mfma_f32_16x16x32_bf16 v[112:115], a[64:67], v[220:223], v[112:115]
    v_mfma_f32_16x16x32_bf16 v[116:119], a[68:71], v[220:223], v[116:119]
    buffer_load_dwordx4 v[212:215], v9, s[40:43], s49 offen
    v_mfma_f32_16x16x32_bf16 v[120:123], a[72:75], v[220:223], v[120:123]
    v_mfma_f32_16x16x32_bf16 v[124:127], a[76:79], v[220:223], v[124:127]
    s_mov_b32 s48, 20480
    buffer_load_dwordx4 a[20:23], v47, s[68:71], s48 offen offset:0
    v_mfma_f32_16x16x32_bf16 v[128:131], a[60:63], v[224:227], v[128:131]
    v_mfma_f32_16x16x32_bf16 v[132:135], a[64:67], v[224:227], v[132:135]
    buffer_load_dwordx4 a[24:27], v47, s[68:71], s48 offen offset:1024
    v_mfma_f32_16x16x32_bf16 v[136:139], a[68:71], v[224:227], v[136:139]
    v_mfma_f32_16x16x32_bf16 v[140:143], a[72:75], v[224:227], v[140:143]
    buffer_load_dwordx4 a[28:31], v47, s[68:71], s48 offen offset:2048
    v_mfma_f32_16x16x32_bf16 v[144:147], a[76:79], v[224:227], v[144:147]
    v_mfma_f32_16x16x32_bf16 v[148:151], a[60:63], v[228:231], v[148:151]
    v_mfma_f32_16x16x32_bf16 v[152:155], a[64:67], v[228:231], v[152:155]
    v_mfma_f32_16x16x32_bf16 v[156:159], a[68:71], v[228:231], v[156:159]
    v_mfma_f32_16x16x32_bf16 v[160:163], a[72:75], v[228:231], v[160:163]
    v_mfma_f32_16x16x32_bf16 v[164:167], a[76:79], v[228:231], v[164:167]
    s_waitcnt vmcnt(28)
    s_mov_b64 exec, 1
    buffer_atomic_add v50, v48, s[64:67], s75 offen offset:2048
    s_mov_b64 exec, -1
    v_mfma_f32_16x16x32_bf16 v[88:91], a[80:83], v[232:235], v[88:91]
    v_mfma_f32_16x16x32_bf16 v[92:95], a[84:87], v[232:235], v[92:95]
    s_mov_b32 s49, 40960
    buffer_load_dwordx4 v[216:219], v6, s[40:43], s49 offen
    v_mfma_f32_16x16x32_bf16 v[96:99], a[88:91], v[232:235], v[96:99]
    v_mfma_f32_16x16x32_bf16 v[100:103], a[92:95], v[232:235], v[100:103]
    buffer_load_dwordx4 v[220:223], v7, s[40:43], s49 offen
    v_mfma_f32_16x16x32_bf16 v[104:107], a[96:99], v[232:235], v[104:107]
    v_mfma_f32_16x16x32_bf16 v[108:111], a[80:83], v[236:239], v[108:111]
    buffer_load_dwordx4 v[224:227], v8, s[40:43], s49 offen
    v_mfma_f32_16x16x32_bf16 v[112:115], a[84:87], v[236:239], v[112:115]
    v_mfma_f32_16x16x32_bf16 v[116:119], a[88:91], v[236:239], v[116:119]
    buffer_load_dwordx4 v[228:231], v9, s[40:43], s49 offen
    v_mfma_f32_16x16x32_bf16 v[120:123], a[92:95], v[236:239], v[120:123]
    v_mfma_f32_16x16x32_bf16 v[124:127], a[96:99], v[236:239], v[124:127]
    buffer_load_dwordx4 a[32:35], v47, s[68:71], s48 offen offset:3072
    v_mfma_f32_16x16x32_bf16 v[128:131], a[80:83], v[240:243], v[128:131]
    v_mfma_f32_16x16x32_bf16 v[132:135], a[84:87], v[240:243], v[132:135]
    buffer_load_dwordx4 a[36:39], v29, s[68:71], s48 offen offset:0
    v_mfma_f32_16x16x32_bf16 v[136:139], a[88:91], v[240:243], v[136:139]
    v_mfma_f32_16x16x32_bf16 v[140:143], a[92:95], v[240:243], v[140:143]
    v_mfma_f32_16x16x32_bf16 v[144:147], a[96:99], v[240:243], v[144:147]
    v_mfma_f32_16x16x32_bf16 v[148:151], a[80:83], v[244:247], v[148:151]
    v_mfma_f32_16x16x32_bf16 v[152:155], a[84:87], v[244:247], v[152:155]
    v_mfma_f32_16x16x32_bf16 v[156:159], a[88:91], v[244:247], v[156:159]
    v_mfma_f32_16x16x32_bf16 v[160:163], a[92:95], v[244:247], v[160:163]
    v_mfma_f32_16x16x32_bf16 v[164:167], a[96:99], v[244:247], v[164:167]
    s_waitcnt vmcnt(31)
    v_mfma_f32_16x16x32_bf16 v[88:91], a[100:103], v[56:59], v[88:91]
    v_mfma_f32_16x16x32_bf16 v[92:95], a[104:107], v[56:59], v[92:95]
    s_mov_b32 s49, 45056
    buffer_load_dwordx4 v[232:235], v6, s[40:43], s49 offen
    v_mfma_f32_16x16x32_bf16 v[96:99], a[108:111], v[56:59], v[96:99]
    v_mfma_f32_16x16x32_bf16 v[100:103], a[112:115], v[56:59], v[100:103]
    buffer_load_dwordx4 v[236:239], v7, s[40:43], s49 offen
    v_mfma_f32_16x16x32_bf16 v[104:107], a[116:119], v[56:59], v[104:107]
    v_mfma_f32_16x16x32_bf16 v[108:111], a[100:103], v[60:63], v[108:111]
    buffer_load_dwordx4 v[240:243], v8, s[40:43], s49 offen
    v_mfma_f32_16x16x32_bf16 v[112:115], a[104:107], v[60:63], v[112:115]
    v_mfma_f32_16x16x32_bf16 v[116:119], a[108:111], v[60:63], v[116:119]
    buffer_load_dwordx4 v[244:247], v9, s[40:43], s49 offen
    v_mfma_f32_16x16x32_bf16 v[120:123], a[112:115], v[60:63], v[120:123]
    v_mfma_f32_16x16x32_bf16 v[124:127], a[116:119], v[60:63], v[124:127]
    s_mov_b32 s48, 40960
    buffer_load_dwordx4 a[40:43], v47, s[68:71], s48 offen offset:0
    v_mfma_f32_16x16x32_bf16 v[128:131], a[100:103], v[64:67], v[128:131]
    v_mfma_f32_16x16x32_bf16 v[132:135], a[104:107], v[64:67], v[132:135]
    buffer_load_dwordx4 a[44:47], v47, s[68:71], s48 offen offset:1024
    v_mfma_f32_16x16x32_bf16 v[136:139], a[108:111], v[64:67], v[136:139]
    v_mfma_f32_16x16x32_bf16 v[140:143], a[112:115], v[64:67], v[140:143]
    buffer_load_dwordx4 a[48:51], v47, s[68:71], s48 offen offset:2048
    v_mfma_f32_16x16x32_bf16 v[144:147], a[116:119], v[64:67], v[144:147]
    v_mfma_f32_16x16x32_bf16 v[148:151], a[100:103], v[68:71], v[148:151]
    v_mfma_f32_16x16x32_bf16 v[152:155], a[104:107], v[68:71], v[152:155]
    v_mfma_f32_16x16x32_bf16 v[156:159], a[108:111], v[68:71], v[156:159]
    v_mfma_f32_16x16x32_bf16 v[160:163], a[112:115], v[68:71], v[160:163]
    v_mfma_f32_16x16x32_bf16 v[164:167], a[116:119], v[68:71], v[164:167]
    s_waitcnt vmcnt(34)
    v_mfma_f32_16x16x32_bf16 v[88:91], a[120:123], v[72:75], v[88:91]
    v_mfma_f32_16x16x32_bf16 v[92:95], a[124:127], v[72:75], v[92:95]
    buffer_load_dword v51, v49, s[64:67], 0 offen offset:2048 sc1
    v_mfma_f32_16x16x32_bf16 v[96:99], a[128:131], v[72:75], v[96:99]
    v_mfma_f32_16x16x32_bf16 v[100:103], a[132:135], v[72:75], v[100:103]
    buffer_load_dwordx4 a[52:55], v47, s[68:71], s48 offen offset:3072
    v_mfma_f32_16x16x32_bf16 v[104:107], a[136:139], v[72:75], v[104:107]
    v_mfma_f32_16x16x32_bf16 v[108:111], a[120:123], v[76:79], v[108:111]
    buffer_load_dwordx4 a[56:59], v29, s[68:71], s48 offen offset:0
    v_mfma_f32_16x16x32_bf16 v[112:115], a[124:127], v[76:79], v[112:115]
    v_mfma_f32_16x16x32_bf16 v[116:119], a[128:131], v[76:79], v[116:119]
    v_mfma_f32_16x16x32_bf16 v[120:123], a[132:135], v[76:79], v[120:123]
    v_mfma_f32_16x16x32_bf16 v[124:127], a[136:139], v[76:79], v[124:127]
    v_mfma_f32_16x16x32_bf16 v[128:131], a[120:123], v[80:83], v[128:131]
    v_mfma_f32_16x16x32_bf16 v[132:135], a[124:127], v[80:83], v[132:135]
    v_mfma_f32_16x16x32_bf16 v[136:139], a[128:131], v[80:83], v[136:139]
    v_mfma_f32_16x16x32_bf16 v[140:143], a[132:135], v[80:83], v[140:143]
    v_mfma_f32_16x16x32_bf16 v[144:147], a[136:139], v[80:83], v[144:147]
    v_mfma_f32_16x16x32_bf16 v[148:151], a[120:123], v[84:87], v[148:151]
    v_mfma_f32_16x16x32_bf16 v[152:155], a[124:127], v[84:87], v[152:155]
    v_mfma_f32_16x16x32_bf16 v[156:159], a[128:131], v[84:87], v[156:159]
    v_mfma_f32_16x16x32_bf16 v[160:163], a[132:135], v[84:87], v[160:163]
    v_mfma_f32_16x16x32_bf16 v[164:167], a[136:139], v[84:87], v[164:167]
    s_waitcnt vmcnt(33)
    v_mfma_f32_16x16x32_bf16 v[88:91], a[140:143], v[168:171], v[88:91]
    v_mfma_f32_16x16x32_bf16 v[92:95], a[144:147], v[168:171], v[92:95]
    s_mov_b32 s48, 61440
    buffer_load_dwordx4 a[60:63], v47, s[68:71], s48 offen offset:0
    v_mfma_f32_16x16x32_bf16 v[96:99], a[148:151], v[168:171], v[96:99]
    v_mfma_f32_16x16x32_bf16 v[100:103], a[152:155], v[168:171], v[100:103]
    buffer_load_dwordx4 a[64:67], v47, s[68:71], s48 offen offset:1024
    v_mfma_f32_16x16x32_bf16 v[104:107], a[156:159], v[168:171], v[104:107]
    v_mfma_f32_16x16x32_bf16 v[108:111], a[140:143], v[172:175], v[108:111]
    buffer_load_dwordx4 a[68:71], v47, s[68:71], s48 offen offset:2048
    v_mfma_f32_16x16x32_bf16 v[112:115], a[144:147], v[172:175], v[112:115]
    v_mfma_f32_16x16x32_bf16 v[116:119], a[148:151], v[172:175], v[116:119]
    v_mfma_f32_16x16x32_bf16 v[120:123], a[152:155], v[172:175], v[120:123]
    v_mfma_f32_16x16x32_bf16 v[124:127], a[156:159], v[172:175], v[124:127]
    v_mfma_f32_16x16x32_bf16 v[128:131], a[140:143], v[176:179], v[128:131]
    v_mfma_f32_16x16x32_bf16 v[132:135], a[144:147], v[176:179], v[132:135]
    v_mfma_f32_16x16x32_bf16 v[136:139], a[148:151], v[176:179], v[136:139]
    v_mfma_f32_16x16x32_bf16 v[140:143], a[152:155], v[176:179], v[140:143]
    v_mfma_f32_16x16x32_bf16 v[144:147], a[156:159], v[176:179], v[144:147]
    v_mfma_f32_16x16x32_bf16 v[148:151], a[140:143], v[180:183], v[148:151]
    v_mfma_f32_16x16x32_bf16 v[152:155], a[144:147], v[180:183], v[152:155]
    v_mfma_f32_16x16x32_bf16 v[156:159], a[148:151], v[180:183], v[156:159]
    v_mfma_f32_16x16x32_bf16 v[160:163], a[152:155], v[180:183], v[160:163]
    v_mfma_f32_16x16x32_bf16 v[164:167], a[156:159], v[180:183], v[164:167]
    s_waitcnt vmcnt(5)
    v_readfirstlane_b32 s60, v51
    s_cmp_ge_u32 s60, 64
    s_cselect_b32 s75, 0, 0x7f000000
    v_mfma_f32_16x16x32_bf16 v[88:91], a[160:163], v[184:187], v[88:91]
    v_mfma_f32_16x16x32_bf16 v[92:95], a[164:167], v[184:187], v[92:95]
    s_or_b32 s49, s75, 0
    buffer_load_dwordx4 v[56:59], v10, s[36:39], s49 offen
    v_mfma_f32_16x16x32_bf16 v[96:99], a[168:171], v[184:187], v[96:99]
    v_mfma_f32_16x16x32_bf16 v[100:103], a[172:175], v[184:187], v[100:103]
    buffer_load_dwordx4 v[60:63], v11, s[36:39], s49 offen
    v_mfma_f32_16x16x32_bf16 v[104:107], a[176:179], v[184:187], v[104:107]
    v_mfma_f32_16x16x32_bf16 v[108:111], a[160:163], v[188:191], v[108:111]
    buffer_load_dwordx4 v[64:67], v12, s[36:39], s49 offen
    v_mfma_f32_16x16x32_bf16 v[112:115], a[164:167], v[188:191], v[112:115]
    v_mfma_f32_16x16x32_bf16 v[116:119], a[168:171], v[188:191], v[116:119]
    buffer_load_dwordx4 v[68:71], v13, s[36:39], s49 offen
    v_mfma_f32_16x16x32_bf16 v[120:123], a[172:175], v[188:191], v[120:123]
    v_mfma_f32_16x16x32_bf16 v[124:127], a[176:179], v[188:191], v[124:127]
    buffer_load_dwordx4 a[72:75], v47, s[68:71], s48 offen offset:3072
    v_mfma_f32_16x16x32_bf16 v[128:131], a[160:163], v[192:195], v[128:131]
    v_mfma_f32_16x16x32_bf16 v[132:135], a[164:167], v[192:195], v[132:135]
    buffer_load_dwordx4 a[76:79], v29, s[68:71], s48 offen offset:0
    v_mfma_f32_16x16x32_bf16 v[136:139], a[168:171], v[192:195], v[136:139]
    v_mfma_f32_16x16x32_bf16 v[140:143], a[172:175], v[192:195], v[140:143]
    v_mfma_f32_16x16x32_bf16 v[144:147], a[176:179], v[192:195], v[144:147]
    v_mfma_f32_16x16x32_bf16 v[148:151], a[160:163], v[196:199], v[148:151]
    v_mfma_f32_16x16x32_bf16 v[152:155], a[164:167], v[196:199], v[152:155]
    v_mfma_f32_16x16x32_bf16 v[156:159], a[168:171], v[196:199], v[156:159]
    v_mfma_f32_16x16x32_bf16 v[160:163], a[172:175], v[196:199], v[160:163]
    v_mfma_f32_16x16x32_bf16 v[164:167], a[176:179], v[196:199], v[164:167]
    v_mfma_f32_16x16x32_bf16 v[88:91], a[180:183], v[200:203], v[88:91]
    v_mfma_f32_16x16x32_bf16 v[92:95], a[184:187], v[200:203], v[92:95]
    s_or_b32 s49, s75, 4096
    buffer_load_dwordx4 v[72:75], v10, s[36:39], s49 offen
    v_mfma_f32_16x16x32_bf16 v[96:99], a[188:191], v[200:203], v[96:99]
    v_mfma_f32_16x16x32_bf16 v[100:103], a[192:195], v[200:203], v[100:103]
    buffer_load_dwordx4 v[76:79], v11, s[36:39], s49 offen
    v_mfma_f32_16x16x32_bf16 v[104:107], a[196:199], v[200:203], v[104:107]
    v_mfma_f32_16x16x32_bf16 v[108:111], a[180:183], v[204:207], v[108:111]
    buffer_load_dwordx4 v[80:83], v12, s[36:39], s49 offen
    v_mfma_f32_16x16x32_bf16 v[112:115], a[184:187], v[204:207], v[112:115]
    v_mfma_f32_16x16x32_bf16 v[116:119], a[188:191], v[204:207], v[116:119]
    buffer_load_dwordx4 v[84:87], v13, s[36:39], s49 offen
    v_mfma_f32_16x16x32_bf16 v[120:123], a[192:195], v[204:207], v[120:123]
    v_mfma_f32_16x16x32_bf16 v[124:127], a[196:199], v[204:207], v[124:127]
    s_mov_b32 s48, 81920
    buffer_load_dwordx4 a[80:83], v47, s[68:71], s48 offen offset:0
    v_mfma_f32_16x16x32_bf16 v[128:131], a[180:183], v[208:211], v[128:131]
    v_mfma_f32_16x16x32_bf16 v[132:135], a[184:187], v[208:211], v[132:135]
    buffer_load_dwordx4 a[84:87], v47, s[68:71], s48 offen offset:1024
    v_mfma_f32_16x16x32_bf16 v[136:139], a[188:191], v[208:211], v[136:139]
    v_mfma_f32_16x16x32_bf16 v[140:143], a[192:195], v[208:211], v[140:143]
    buffer_load_dwordx4 a[88:91], v47, s[68:71], s48 offen offset:2048
    v_mfma_f32_16x16x32_bf16 v[144:147], a[196:199], v[208:211], v[144:147]
    v_mfma_f32_16x16x32_bf16 v[148:151], a[180:183], v[212:215], v[148:151]
    v_mfma_f32_16x16x32_bf16 v[152:155], a[184:187], v[212:215], v[152:155]
    v_mfma_f32_16x16x32_bf16 v[156:159], a[188:191], v[212:215], v[156:159]
    v_mfma_f32_16x16x32_bf16 v[160:163], a[192:195], v[212:215], v[160:163]
    v_mfma_f32_16x16x32_bf16 v[164:167], a[196:199], v[212:215], v[164:167]
    v_mfma_f32_16x16x32_bf16 v[88:91], a[200:203], v[216:219], v[88:91]
    v_mfma_f32_16x16x32_bf16 v[92:95], a[204:207], v[216:219], v[92:95]
    s_or_b32 s49, s75, 8192
    buffer_load_dwordx4 v[168:171], v10, s[36:39], s49 offen
    v_mfma_f32_16x16x32_bf16 v[96:99], a[208:211], v[216:219], v[96:99]
    v_mfma_f32_16x16x32_bf16 v[100:103], a[212:215], v[216:219], v[100:103]
    buffer_load_dwordx4 v[172:175], v11, s[36:39], s49 offen
    v_mfma_f32_16x16x32_bf16 v[104:107], a[216:219], v[216:219], v[104:107]
    v_mfma_f32_16x16x32_bf16 v[108:111], a[200:203], v[220:223], v[108:111]
    buffer_load_dwordx4 v[176:179], v12, s[36:39], s49 offen
    v_mfma_f32_16x16x32_bf16 v[112:115], a[204:207], v[220:223], v[112:115]
    v_mfma_f32_16x16x32_bf16 v[116:119], a[208:211], v[220:223], v[116:119]
    buffer_load_dwordx4 v[180:183], v13, s[36:39], s49 offen
    v_mfma_f32_16x16x32_bf16 v[120:123], a[212:215], v[220:223], v[120:123]
    v_mfma_f32_16x16x32_bf16 v[124:127], a[216:219], v[220:223], v[124:127]
    buffer_load_dwordx4 a[92:95], v47, s[68:71], s48 offen offset:3072
    v_mfma_f32_16x16x32_bf16 v[128:131], a[200:203], v[224:227], v[128:131]
    v_mfma_f32_16x16x32_bf16 v[132:135], a[204:207], v[224:227], v[132:135]
    buffer_load_dwordx4 a[96:99], v29, s[68:71], s48 offen offset:0
    v_mfma_f32_16x16x32_bf16 v[136:139], a[208:211], v[224:227], v[136:139]
    v_mfma_f32_16x16x32_bf16 v[140:143], a[212:215], v[224:227], v[140:143]
    v_mfma_f32_16x16x32_bf16 v[144:147], a[216:219], v[224:227], v[144:147]
    v_mfma_f32_16x16x32_bf16 v[148:151], a[200:203], v[228:231], v[148:151]
    v_mfma_f32_16x16x32_bf16 v[152:155], a[204:207], v[228:231], v[152:155]
    v_mfma_f32_16x16x32_bf16 v[156:159], a[208:211], v[228:231], v[156:159]
    v_mfma_f32_16x16x32_bf16 v[160:163], a[212:215], v[228:231], v[160:163]
    v_mfma_f32_16x16x32_bf16 v[164:167], a[216:219], v[228:231], v[164:167]
    v_mfma_f32_16x16x32_bf16 v[88:91], a[220:223], v[232:235], v[88:91]
    v_mfma_f32_16x16x32_bf16 v[92:95], a[224:227], v[232:235], v[92:95]
    s_or_b32 s49, s75, 12288
    buffer_load_dwordx4 v[184:187], v10, s[36:39], s49 offen
    v_mfma_f32_16x16x32_bf16 v[96:99], a[228:231], v[232:235], v[96:99]
    v_mfma_f32_16x16x32_bf16 v[100:103], a[232:235], v[232:235], v[100:103]
    buffer_load_dwordx4 v[188:191], v11, s[36:39], s49 offen
    v_mfma_f32_16x16x32_bf16 v[104:107], a[236:239], v[232:235], v[104:107]
    v_mfma_f32_16x16x32_bf16 v[108:111], a[220:223], v[236:239], v[108:111]
    buffer_load_dwordx4 v[192:195], v12, s[36:39], s49 offen
    v_mfma_f32_16x16x32_bf16 v[112:115], a[224:227], v[236:239], v[112:115]
    v_mfma_f32_16x16x32_bf16 v[116:119], a[228:231], v[236:239], v[116:119]
    buffer_load_dwordx4 v[196:199], v13, s[36:39], s49 offen
    v_mfma_f32_16x16x32_bf16 v[120:123], a[232:235], v[236:239], v[120:123]
    v_mfma_f32_16x16x32_bf16 v[124:127], a[236:239], v[236:239], v[124:127]
    v_mfma_f32_16x16x32_bf16 v[128:131], a[220:223], v[240:243], v[128:131]
    v_mfma_f32_16x16x32_bf16 v[132:135], a[224:227], v[240:243], v[132:135]
    v_mfma_f32_16x16x32_bf16 v[136:139], a[228:231], v[240:243], v[136:139]
    v_mfma_f32_16x16x32_bf16 v[140:143], a[232:235], v[240:243], v[140:143]
    v_mfma_f32_16x16x32_bf16 v[144:147], a[236:239], v[240:243], v[144:147]
    v_mfma_f32_16x16x32_bf16 v[148:151], a[220:223], v[244:247], v[148:151]
    v_mfma_f32_16x16x32_bf16 v[152:155], a[224:227], v[244:247], v[152:155]
    v_mfma_f32_16x16x32_bf16 v[156:159], a[228:231], v[244:247], v[156:159]
    v_mfma_f32_16x16x32_bf16 v[160:163], a[232:235], v[244:247], v[160:163]
    v_mfma_f32_16x16x32_bf16 v[164:167], a[236:239], v[244:247], v[164:167]
    s_cmp_eq_u32 s75, 0
    s_cbranch_scc1 k1_of
    s_mov_b32 s61, 0
k1_o_s:
    buffer_load_dword v51, v49, s[64:67], 0 offen offset:2048 sc1
    s_waitcnt vmcnt(0)
    v_readfirstlane_b32 s60, v51
    s_add_u32 s61, s61, 1
    s_cmp_ge_u32 s60, 64
    s_cbranch_scc1 k1_o_e
    s_cmp_lt_u32 s61, 50000
    s_cbranch_scc1 k1_o_s
k1_o_e:
    s_mov_b32 s49, 0
    buffer_load_dwordx4 v[56:59], v10, s[36:39], s49 offen
    buffer_load_dwordx4 v[60:63], v11, s[36:39], s49 offen
    buffer_load_dwordx4 v[64:67], v12, s[36:39], s49 offen
    buffer_load_dwordx4 v[68:71], v13, s[36:39], s49 offen
    s_mov_b32 s49, 4096
    buffer_load_dwordx4 v[72:75], v10, s[36:39], s49 offen
    buffer_load_dwordx4 v[76:79], v11, s[36:39], s49 offen
    buffer_load_dwordx4 v[80:83], v12, s[36:39], s49 offen
    buffer_load_dwordx4 v[84:87], v13, s[36:39], s49 offen
    s_mov_b32 s49, 8192
    buffer_load_dwordx4 v[168:171], v10, s[36:39], s49 offen
    buffer_load_dwordx4 v[172:175], v11, s[36:39], s49 offen
    buffer_load_dwordx4 v[176:179], v12, s[36:39], s49 offen
    buffer_load_dwordx4 v[180:183], v13, s[36:39], s49 offen
    s_mov_b32 s49, 12288
    buffer_load_dwordx4 v[184:187], v10, s[36:39], s49 offen
    buffer_load_dwordx4 v[188:191], v11, s[36:39], s49 offen
    buffer_load_dwordx4 v[192:195], v12, s[36:39], s49 offen
    buffer_load_dwordx4 v[196:199], v13, s[36:39], s49 offen
    s_waitcnt vmcnt(0)
k1_of:
    s_waitcnt vmcnt(19)
    v_mfma_f32_16x16x32_bf16 a[100:103], a[0:3], v[56:59], 0
    v_mfma_f32_16x16x32_bf16 a[104:107], a[4:7], v[56:59], 0
    s_mov_b32 s49, 16384
    buffer_load_dwordx4 v[200:203], v10, s[36:39], s49 offen
    v_mfma_f32_16x16x32_bf16 a[108:111], a[8:11], v[56:59], 0
    v_mfma_f32_16x16x32_bf16 a[112:115], a[12:15], v[56:59], 0
    buffer_load_dwordx4 v[204:207], v11, s[36:39], s49 offen
    v_mfma_f32_16x16x32_bf16 a[116:119], a[16:19], v[56:59], 0
    v_mfma_f32_16x16x32_bf16 a[120:123], a[0:3], v[60:63], 0
    buffer_load_dwordx4 v[208:211], v12, s[36:39], s49 offen
    v_mfma_f32_16x16x32_bf16 a[124:127], a[4:7], v[60:63], 0
    v_mfma_f32_16x16x32_bf16 a[128:131], a[8:11], v[60:63], 0
    buffer_load_dwordx4 v[212:215], v13, s[36:39], s49 offen
    v_mfma_f32_16x16x32_bf16 a[132:135], a[12:15], v[60:63], 0
    v_mfma_f32_16x16x32_bf16 a[136:139], a[16:19], v[60:63], 0
    ds_write_b128 v15, v[108:111] offset:0
    v_mfma_f32_16x16x32_bf16 a[140:143], a[0:3], v[64:67], 0
    v_mfma_f32_16x16x32_bf16 a[144:147], a[4:7], v[64:67], 0
    ds_write_b128 v15, v[112:115] offset:1024
    v_mfma_f32_16x16x32_bf16 a[148:151], a[8:11], v[64:67], 0
    v_mfma_f32_16x16x32_bf16 a[152:155], a[12:15], v[64:67], 0
    ds_write_b128 v15, v[116:119] offset:2048
    v_mfma_f32_16x16x32_bf16 a[156:159], a[16:19], v[64:67], 0
    v_mfma_f32_16x16x32_bf16 a[160:163], a[0:3], v[68:71], 0
    ds_write_b128 v15, v[120:123] offset:3072
    v_mfma_f32_16x16x32_bf16 a[164:167], a[4:7], v[68:71], 0
    v_mfma_f32_16x16x32_bf16 a[168:171], a[8:11], v[68:71], 0
    ds_write_b128 v15, v[124:127] offset:4096
    v_mfma_f32_16x16x32_bf16 a[172:175], a[12:15], v[68:71], 0
    v_mfma_f32_16x16x32_bf16 a[176:179], a[16:19], v[68:71], 0
    s_waitcnt vmcnt(17)
    v_mfma_f32_16x16x32_bf16 a[100:103], a[20:23], v[72:75], a[100:103]
    v_mfma_f32_16x16x32_bf16 a[104:107], a[24:27], v[72:75], a[104:107]
    buffer_load_dwordx2 v[20:21], v14, s[20:23], 0 offen offset:0
    v_mfma_f32_16x16x32_bf16 a[108:111], a[28:31], v[72:75], a[108:111]
    v_mfma_f32_16x16x32_bf16 a[112:115], a[32:35], v[72:75], a[112:115]
    buffer_load_dwordx2 v[22:23], v14, s[20:23], 0 offen offset:32
    v_mfma_f32_16x16x32_bf16 a[116:119], a[36:39], v[72:75], a[116:119]
    v_mfma_f32_16x16x32_bf16 a[120:123], a[20:23], v[76:79], a[120:123]
    buffer_load_dwordx2 v[24:25], v14, s[20:23], 0 offen offset:64
    v_mfma_f32_16x16x32_bf16 a[124:127], a[24:27], v[76:79], a[124:127]
    v_mfma_f32_16x16x32_bf16 a[128:131], a[28:31], v[76:79], a[128:131]
    buffer_load_dwordx2 v[26:27], v14, s[20:23], 0 offen offset:96
    v_mfma_f32_16x16x32_bf16 a[132:135], a[32:35], v[76:79], a[132:135]
    v_mfma_f32_16x16x32_bf16 a[136:139], a[36:39], v[76:79], a[136:139]
    buffer_load_dwordx2 v[28:29], v14, s[20:23], 0 offen offset:128
    v_mfma_f32_16x16x32_bf16 a[140:143], a[20:23], v[80:83], a[140:143]
    v_mfma_f32_16x16x32_bf16 a[144:147], a[24:27], v[80:83], a[144:147]
    ds_write_b128 v16, v[128:131] offset:0
    v_mfma_f32_16x16x32_bf16 a[148:151], a[28:31], v[80:83], a[148:151]
    v_mfma_f32_16x16x32_bf16 a[152:155], a[32:35], v[80:83], a[152:155]
    ds_write_b128 v16, v[132:135] offset:1024
    v_mfma_f32_16x16x32_bf16 a[156:159], a[36:39], v[80:83], a[156:159]
    v_mfma_f32_16x16x32_bf16 a[160:163], a[20:23], v[84:87], a[160:163]
    ds_write_b128 v16, v[136:139] offset:2048
    v_mfma_f32_16x16x32_bf16 a[164:167], a[24:27], v[84:87], a[164:167]
    v_mfma_f32_16x16x32_bf16 a[168:171], a[28:31], v[84:87], a[168:171]
    ds_write_b128 v16, v[140:143] offset:3072
    v_mfma_f32_16x16x32_bf16 a[172:175], a[32:35], v[84:87], a[172:175]
    v_mfma_f32_16x16x32_bf16 a[176:179], a[36:39], v[84:87], a[176:179]
    ds_write_b128 v16, v[144:147] offset:4096
    s_waitcnt vmcnt(15)
    v_mfma_f32_16x16x32_bf16 a[100:103], a[40:43], v[168:171], a[100:103]
    v_mfma_f32_16x16x32_bf16 a[104:107], a[44:47], v[168:171], a[104:107]
    ds_write_b128 v17, v[148:151] offset:0
    v_mfma_f32_16x16x32_bf16 a[108:111], a[48:51], v[168:171], a[108:111]
    v_mfma_f32_16x16x32_bf16 a[112:115], a[52:55], v[168:171], a[112:115]
    ds_write_b128 v17, v[152:155] offset:1024
    v_mfma_f32_16x16x32_bf16 a[116:119], a[56:59], v[168:171], a[116:119]
    v_mfma_f32_16x16x32_bf16 a[120:123], a[40:43], v[172:175], a[120:123]
    ds_write_b128 v17, v[156:159] offset:2048
    v_mfma_f32_16x16x32_bf16 a[124:127], a[44:47], v[172:175], a[124:127]
    v_mfma_f32_16x16x32_bf16 a[128:131], a[48:51], v[172:175], a[128:131]
    ds_write_b128 v17, v[160:163] offset:3072
    v_mfma_f32_16x16x32_bf16 a[132:135], a[52:55], v[172:175], a[132:135]
    v_mfma_f32_16x16x32_bf16 a[136:139], a[56:59], v[172:175], a[136:139]
    ds_write_b128 v17, v[164:167] offset:4096
    v_mfma_f32_16x16x32_bf16 a[140:143], a[40:43], v[176:179], a[140:143]
    v_mfma_f32_16x16x32_bf16 a[144:147], a[44:47], v[176:179], a[144:147]
    v_mfma_f32_16x16x32_bf16 a[148:151], a[48:51], v[176:179], a[148:151]
    v_mfma_f32_16x16x32_bf16 a[152:155], a[52:55], v[176:179], a[152:155]
    v_mfma_f32_16x16x32_bf16 a[156:159], a[56:59], v[176:179], a[156:159]
    v_mfma_f32_16x16x32_bf16 a[160:163], a[40:43], v[180:183], a[160:163]
    v_mfma_f32_16x16x32_bf16 a[164:167], a[44:47], v[180:183], a[164:167]
    v_mfma_f32_16x16x32_bf16 a[168:171], a[48:51], v[180:183], a[168:171]
    v_mfma_f32_16x16x32_bf16 a[172:175], a[52:55], v[180:183], a[172:175]
    v_mfma_f32_16x16x32_bf16 a[176:179], a[56:59], v[180:183], a[176:179]
    s_waitcnt lgkmcnt(0)
    s_barrier
    s_waitcnt vmcnt(9)
    v_mfma_f32_16x16x32_bf16 a[100:103], a[60:63], v[184:187], a[100:103]
    v_mfma_f32_16x16x32_bf16 a[104:107], a[64:67], v[184:187], a[104:107]
    ds_read_b128 v[108:111], v18 offset:0
    v_mfma_f32_16x16x32_bf16 a[108:111], a[68:71], v[184:187], a[108:111]
    v_mfma_f32_16x16x32_bf16 a[112:115], a[72:75], v[184:187], a[112:115]
    ds_read_b128 v[112:115], v18 offset:5120
    v_mfma_f32_16x16x32_bf16 a[116:119], a[76:79], v[184:187], a[116:119]
    v_mfma_f32_16x16x32_bf16 a[120:123], a[60:63], v[188:191], a[120:123]
    ds_read_b128 v[116:119], v18 offset:10240
    v_mfma_f32_16x16x32_bf16 a[124:127], a[64:67], v[188:191], a[124:127]
    v_mfma_f32_16x16x32_bf16 a[128:131], a[68:71], v[188:191], a[128:131]
    ds_read_b128 v[120:123], v18 offset:1024
    v_mfma_f32_16x16x32_bf16 a[132:135], a[72:75], v[188:191], a[132:135]
    v_mfma_f32_16x16x32_bf16 a[136:139], a[76:79], v[188:191], a[136:139]
    ds_read_b128 v[124:127], v18 offset:6144
    v_mfma_f32_16x16x32_bf16 a[140:143], a[60:63], v[192:195], a[140:143]
    v_mfma_f32_16x16x32_bf16 a[144:147], a[64:67], v[192:195], a[144:147]
    ds_read_b128 v[128:131], v18 offset:11264
    v_mfma_f32_16x16x32_bf16 a[148:151], a[68:71], v[192:195], a[148:151]
    v_mfma_f32_16x16x32_bf16 a[152:155], a[72:75], v[192:195], a[152:155]
    ds_read_b128 v[132:135], v18 offset:2048
    v_mfma_f32_16x16x32_bf16 a[156:159], a[76:79], v[192:195], a[156:159]
    v_mfma_f32_16x16x32_bf16 a[160:163], a[60:63], v[196:199], a[160:163]
    ds_read_b128 v[136:139], v18 offset:7168
    v_mfma_f32_16x16x32_bf16 a[164:167], a[64:67], v[196:199], a[164:167]
    v_mfma_f32_16x16x32_bf16 a[168:171], a[68:71], v[196:199], a[168:171]
    v_mfma_f32_16x16x32_bf16 a[172:175], a[72:75], v[196:199], a[172:175]
    v_mfma_f32_16x16x32_bf16 a[176:179], a[76:79], v[196:199], a[176:179]
    s_waitcnt vmcnt(5)
    v_mfma_f32_16x16x32_bf16 a[100:103], a[80:83], v[200:203], a[100:103]
    v_mfma_f32_16x16x32_bf16 a[104:107], a[84:87], v[200:203], a[104:107]
    ds_read_b128 v[140:143], v18 offset:12288
    v_mfma_f32_16x16x32_bf16 a[108:111], a[88:91], v[200:203], a[108:111]
    v_mfma_f32_16x16x32_bf16 a[112:115], a[92:95], v[200:203], a[112:115]
    ds_read_b128 v[144:147], v18 offset:3072
    v_mfma_f32_16x16x32_bf16 a[116:119], a[96:99], v[200:203], a[116:119]
    v_mfma_f32_16x16x32_bf16 a[120:123], a[80:83], v[204:207], a[120:123]
    ds_read_b128 v[148:151], v18 offset:8192
    v_mfma_f32_16x16x32_bf16 a[124:127], a[84:87], v[204:207], a[124:127]
    v_mfma_f32_16x16x32_bf16 a[128:131], a[88:91], v[204:207], a[128:131]
    ds_read_b128 v[152:155], v18 offset:13312
    v_mfma_f32_16x16x32_bf16 a[132:135], a[92:95], v[204:207], a[132:135]
    v_mfma_f32_16x16x32_bf16 a[136:139], a[96:99], v[204:207], a[136:139]
    ds_read_b128 v[156:159], v18 offset:4096
    v_mfma_f32_16x16x32_bf16 a[140:143], a[80:83], v[208:211], a[140:143]
    v_mfma_f32_16x16x32_bf16 a[144:147], a[84:87], v[208:211], a[144:147]
    ds_read_b128 v[160:163], v18 offset:9216
    v_mfma_f32_16x16x32_bf16 a[148:151], a[88:91], v[208:211], a[148:151]
    v_mfma_f32_16x16x32_bf16 a[152:155], a[92:95], v[208:211], a[152:155]
    ds_read_b128 v[164:167], v18 offset:14336
    v_mfma_f32_16x16x32_bf16 a[156:159], a[96:99], v[208:211], a[156:159]
    v_mfma_f32_16x16x32_bf16 a[160:163], a[80:83], v[212:215], a[160:163]
    v_mfma_f32_16x16x32_bf16 a[164:167], a[84:87], v[212:215], a[164:167]
    v_mfma_f32_16x16x32_bf16 a[168:171], a[88:91], v[212:215], a[168:171]
    v_mfma_f32_16x16x32_bf16 a[172:175], a[92:95], v[212:215], a[172:175]
    v_mfma_f32_16x16x32_bf16 a[176:179], a[96:99], v[212:215], a[176:179]
    s_nop 7
    ds_write_b128 v15, a[120:123] offset:15360
    ds_write_b128 v15, a[124:127] offset:16384
    ds_write_b128 v15, a[128:131] offset:17408
    ds_write_b128 v15, a[132:135] offset:18432
    ds_write_b128 v15, a[136:139] offset:19456
    ds_write_b128 v16, a[140:143] offset:15360
    ds_write_b128 v16, a[144:147] offset:16384
    ds_write_b128 v16, a[148:151] offset:17408
    ds_write_b128 v16, a[152:155] offset:18432
    ds_write_b128 v16, a[156:159] offset:19456
    ds_write_b128 v17, a[160:163] offset:15360
    ds_write_b128 v17, a[164:167] offset:16384
    ds_write_b128 v17, a[168:171] offset:17408
    ds_write_b128 v17, a[172:175] offset:18432
    ds_write_b128 v17, a[176:179] offset:19456
    s_waitcnt lgkmcnt(15)
    v_pk_add_f32 v[108:109], v[108:109], v[112:113]
    v_pk_add_f32 v[110:111], v[110:111], v[114:115]
    v_pk_add_f32 v[88:89], v[88:89], v[116:117]
    v_pk_add_f32 v[90:91], v[90:91], v[118:119]
    v_pk_add_f32 v[88:89], v[88:89], v[108:109]
    v_pk_add_f32 v[90:91], v[90:91], v[110:111]
    v_cvt_pk_bf16_f32 v32, v88, v89
    v_lshlrev_b32 v88, 16, v32
    v_and_b32 v89, 0xffff0000, v32
    v_cvt_pk_bf16_f32 v33, v90, v91
    v_lshlrev_b32 v90, 16, v33
    v_and_b32 v91, 0xffff0000, v33
    s_waitcnt lgkmcnt(15)
    v_pk_add_f32 v[120:121], v[120:121], v[124:125]
    v_pk_add_f32 v[122:123], v[122:123], v[126:127]
    v_pk_add_f32 v[92:93], v[92:93], v[128:129]
    v_pk_add_f32 v[94:95], v[94:95], v[130:131]
    v_pk_add_f32 v[92:93], v[92:93], v[120:121]
    v_pk_add_f32 v[94:95], v[94:95], v[122:123]
    v_cvt_pk_bf16_f32 v32, v92, v93
    v_lshlrev_b32 v92, 16, v32
    v_and_b32 v93, 0xffff0000, v32
    v_cvt_pk_bf16_f32 v33, v94, v95
    v_lshlrev_b32 v94, 16, v33
    v_and_b32 v95, 0xffff0000, v33
    s_waitcnt lgkmcnt(0)
    s_barrier
    ds_read_b128 v[168:171], v18 offset:15360
    ds_read_b128 v[172:175], v18 offset:20480
    ds_read_b128 v[176:179], v18 offset:25600
    ds_read_b128 v[180:183], v18 offset:16384
    ds_read_b128 v[184:187], v18 offset:21504
    ds_read_b128 v[188:191], v18 offset:26624
    ds_read_b128 v[192:195], v18 offset:17408
    ds_read_b128 v[196:199], v18 offset:22528
    ds_read_b128 v[200:203], v18 offset:27648
    ds_read_b128 v[204:207], v18 offset:18432
    ds_read_b128 v[208:211], v18 offset:23552
    ds_read_b128 v[212:215], v18 offset:28672
    ds_read_b128 v[216:219], v18 offset:19456
    ds_read_b128 v[220:223], v18 offset:24576
    ds_read_b128 v[224:227], v18 offset:29696
    v_pk_add_f32 v[132:133], v[132:133], v[136:137]
    v_pk_add_f32 v[134:135], v[134:135], v[138:139]
    v_pk_add_f32 v[96:97], v[96:97], v[140:141]
    v_pk_add_f32 v[98:99], v[98:99], v[142:143]
    v_pk_add_f32 v[96:97], v[96:97], v[132:133]
    v_pk_add_f32 v[98:99], v[98:99], v[134:135]
    v_cvt_pk_bf16_f32 v32, v96, v97
    v_lshlrev_b32 v96, 16, v32
    v_and_b32 v97, 0xffff0000, v32
    v_cvt_pk_bf16_f32 v33, v98, v99
    v_lshlrev_b32 v98, 16, v33
    v_and_b32 v99, 0xffff0000, v33
    v_pk_add_f32 v[144:145], v[144:145], v[148:149]
    v_pk_add_f32 v[146:147], v[146:147], v[150:151]
    v_pk_add_f32 v[100:101], v[100:101], v[152:153]
    v_pk_add_f32 v[102:103], v[102:103], v[154:155]
    v_pk_add_f32 v[100:101], v[100:101], v[144:145]
    v_pk_add_f32 v[102:103], v[102:103], v[146:147]
    v_cvt_pk_bf16_f32 v32, v100, v101
    v_lshlrev_b32 v100, 16, v32
    v_and_b32 v101, 0xffff0000, v32
    v_cvt_pk_bf16_f32 v33, v102, v103
    v_lshlrev_b32 v102, 16, v33
    v_and_b32 v103, 0xffff0000, v33
    v_pk_add_f32 v[156:157], v[156:157], v[160:161]
    v_pk_add_f32 v[158:159], v[158:159], v[162:163]
    v_pk_add_f32 v[104:105], v[104:105], v[164:165]
    v_pk_add_f32 v[106:107], v[106:107], v[166:167]
    v_pk_add_f32 v[104:105], v[104:105], v[156:157]
    v_pk_add_f32 v[106:107], v[106:107], v[158:159]
    v_cvt_pk_bf16_f32 v32, v104, v105
    v_lshlrev_b32 v104, 16, v32
    v_and_b32 v105, 0xffff0000, v32
    v_cvt_pk_bf16_f32 v33, v106, v107
    v_lshlrev_b32 v106, 16, v33
    v_and_b32 v107, 0xffff0000, v33
    s_waitcnt vmcnt(0)
    v_accvgpr_read_b32 v52, a100
    v_accvgpr_read_b32 v53, a101
    v_accvgpr_read_b32 v54, a102
    v_accvgpr_read_b32 v55, a103
    v_lshlrev_b32 v228, 16, v20
    v_and_b32 v229, 0xffff0000, v20
    v_lshlrev_b32 v230, 16, v21
    v_and_b32 v231, 0xffff0000, v21
    v_accvgpr_read_b32 v56, a104
    v_accvgpr_read_b32 v57, a105
    v_accvgpr_read_b32 v58, a106
    v_accvgpr_read_b32 v59, a107
    v_lshlrev_b32 v232, 16, v22
    v_and_b32 v233, 0xffff0000, v22
    v_lshlrev_b32 v234, 16, v23
    v_and_b32 v235, 0xffff0000, v23
    v_accvgpr_read_b32 v60, a108
    v_accvgpr_read_b32 v61, a109
    v_accvgpr_read_b32 v62, a110
    v_accvgpr_read_b32 v63, a111
    v_lshlrev_b32 v236, 16, v24
    v_and_b32 v237, 0xffff0000, v24
    v_lshlrev_b32 v238, 16, v25
    v_and_b32 v239, 0xffff0000, v25
    v_accvgpr_read_b32 v64, a112
    v_accvgpr_read_b32 v65, a113
    v_accvgpr_read_b32 v66, a114
    v_accvgpr_read_b32 v67, a115
    v_lshlrev_b32 v240, 16, v26
    v_and_b32 v241, 0xffff0000, v26
    v_lshlrev_b32 v242, 16, v27
    v_and_b32 v243, 0xffff0000, v27
    v_accvgpr_read_b32 v68, a116
    v_accvgpr_read_b32 v69, a117
    v_accvgpr_read_b32 v70, a118
    v_accvgpr_read_b32 v71, a119
    v_lshlrev_b32 v244, 16, v28
    v_and_b32 v245, 0xffff0000, v28
    v_lshlrev_b32 v246, 16, v29
    v_and_b32 v247, 0xffff0000, v29
    s_waitcnt lgkmcnt(12)
    v_pk_add_f32 v[168:169], v[168:169], v[172:173]
    v_pk_add_f32 v[170:171], v[170:171], v[174:175]
    v_pk_add_f32 v[52:53], v[52:53], v[176:177]
    v_pk_add_f32 v[54:55], v[54:55], v[178:179]
    v_pk_add_f32 v[52:53], v[52:53], v[168:169]
    v_pk_add_f32 v[54:55], v[54:55], v[170:171]
    v_cvt_pk_bf16_f32 v32, v52, v53
    v_lshlrev_b32 v52, 16, v32
    v_and_b32 v53, 0xffff0000, v32
    v_cvt_pk_bf16_f32 v33, v54, v55
    v_lshlrev_b32 v54, 16, v33
    v_and_b32 v55, 0xffff0000, v33
    v_pk_add_f32 v[52:53], v[52:53], v[228:229]
    v_pk_add_f32 v[54:55], v[54:55], v[230:231]
    v_cvt_pk_bf16_f32 v32, v52, v53
    v_lshlrev_b32 v52, 16, v32
    v_and_b32 v53, 0xffff0000, v32
    v_cvt_pk_bf16_f32 v33, v54, v55
    v_lshlrev_b32 v54, 16, v33
    v_and_b32 v55, 0xffff0000, v33
    v_pk_add_f32 v[52:53], v[52:53], v[88:89]
    v_pk_add_f32 v[54:55], v[54:55], v[90:91]
    v_cvt_pk_bf16_f32 v72, v52, v53
    v_cvt_pk_bf16_f32 v73, v54, v55
    buffer_store_dwordx2 v[72:73], v14, s[76:79], 0 offen offset:0
    s_waitcnt lgkmcnt(9)
    v_pk_add_f32 v[180:181], v[180:181], v[184:185]
    v_pk_add_f32 v[182:183], v[182:183], v[186:187]
    v_pk_add_f32 v[56:57], v[56:57], v[188:189]
    v_pk_add_f32 v[58:59], v[58:59], v[190:191]
    v_pk_add_f32 v[56:57], v[56:57], v[180:181]
    v_pk_add_f32 v[58:59], v[58:59], v[182:183]
    v_cvt_pk_bf16_f32 v32, v56, v57
    v_lshlrev_b32 v56, 16, v32
    v_and_b32 v57, 0xffff0000, v32
    v_cvt_pk_bf16_f32 v33, v58, v59
    v_lshlrev_b32 v58, 16, v33
    v_and_b32 v59, 0xffff0000, v33
    v_pk_add_f32 v[56:57], v[56:57], v[232:233]
    v_pk_add_f32 v[58:59], v[58:59], v[234:235]
    v_cvt_pk_bf16_f32 v32, v56, v57
    v_lshlrev_b32 v56, 16, v32
    v_and_b32 v57, 0xffff0000, v32
    v_cvt_pk_bf16_f32 v33, v58, v59
    v_lshlrev_b32 v58, 16, v33
    v_and_b32 v59, 0xffff0000, v33
    v_pk_add_f32 v[56:57], v[56:57], v[92:93]
    v_pk_add_f32 v[58:59], v[58:59], v[94:95]
    v_cvt_pk_bf16_f32 v74, v56, v57
    v_cvt_pk_bf16_f32 v75, v58, v59
    buffer_store_dwordx2 v[74:75], v14, s[76:79], 0 offen offset:32
    s_waitcnt lgkmcnt(6)
    v_pk_add_f32 v[192:193], v[192:193], v[196:197]
    v_pk_add_f32 v[194:195], v[194:195], v[198:199]
    v_pk_add_f32 v[60:61], v[60:61], v[200:201]
    v_pk_add_f32 v[62:63], v[62:63], v[202:203]
    v_pk_add_f32 v[60:61], v[60:61], v[192:193]
    v_pk_add_f32 v[62:63], v[62:63], v[194:195]
    v_cvt_pk_bf16_f32 v32, v60, v61
    v_lshlrev_b32 v60, 16, v32
    v_and_b32 v61, 0xffff0000, v32
    v_cvt_pk_bf16_f32 v33, v62, v63
    v_lshlrev_b32 v62, 16, v33
    v_and_b32 v63, 0xffff0000, v33
    v_pk_add_f32 v[60:61], v[60:61], v[236:237]
    v_pk_add_f32 v[62:63], v[62:63], v[238:239]
    v_cvt_pk_bf16_f32 v32, v60, v61
    v_lshlrev_b32 v60, 16, v32
    v_and_b32 v61, 0xffff0000, v32
    v_cvt_pk_bf16_f32 v33, v62, v63
    v_lshlrev_b32 v62, 16, v33
    v_and_b32 v63, 0xffff0000, v33
    v_pk_add_f32 v[60:61], v[60:61], v[96:97]
    v_pk_add_f32 v[62:63], v[62:63], v[98:99]
    v_cvt_pk_bf16_f32 v76, v60, v61
    v_cvt_pk_bf16_f32 v77, v62, v63
    buffer_store_dwordx2 v[76:77], v14, s[76:79], 0 offen offset:64
    s_waitcnt lgkmcnt(3)
    v_pk_add_f32 v[204:205], v[204:205], v[208:209]
    v_pk_add_f32 v[206:207], v[206:207], v[210:211]
    v_pk_add_f32 v[64:65], v[64:65], v[212:213]
    v_pk_add_f32 v[66:67], v[66:67], v[214:215]
    v_pk_add_f32 v[64:65], v[64:65], v[204:205]
    v_pk_add_f32 v[66:67], v[66:67], v[206:207]
    v_cvt_pk_bf16_f32 v32, v64, v65
    v_lshlrev_b32 v64, 16, v32
    v_and_b32 v65, 0xffff0000, v32
    v_cvt_pk_bf16_f32 v33, v66, v67
    v_lshlrev_b32 v66, 16, v33
    v_and_b32 v67, 0xffff0000, v33
    v_pk_add_f32 v[64:65], v[64:65], v[240:241]
    v_pk_add_f32 v[66:67], v[66:67], v[242:243]
    v_cvt_pk_bf16_f32 v32, v64, v65
    v_lshlrev_b32 v64, 16, v32
    v_and_b32 v65, 0xffff0000, v32
    v_cvt_pk_bf16_f32 v33, v66, v67
    v_lshlrev_b32 v66, 16, v33
    v_and_b32 v67, 0xffff0000, v33
    v_pk_add_f32 v[64:65], v[64:65], v[100:101]
    v_pk_add_f32 v[66:67], v[66:67], v[102:103]
    v_cvt_pk_bf16_f32 v78, v64, v65
    v_cvt_pk_bf16_f32 v79, v66, v67
    buffer_store_dwordx2 v[78:79], v14, s[76:79], 0 offen offset:96
    s_waitcnt lgkmcnt(0)
    v_pk_add_f32 v[216:217], v[216:217], v[220:221]
    v_pk_add_f32 v[218:219], v[218:219], v[222:223]
    v_pk_add_f32 v[68:69], v[68:69], v[224:225]
    v_pk_add_f32 v[70:71], v[70:71], v[226:227]
    v_pk_add_f32 v[68:69], v[68:69], v[216:217]
    v_pk_add_f32 v[70:71], v[70:71], v[218:219]
    v_cvt_pk_bf16_f32 v32, v68, v69
    v_lshlrev_b32 v68, 16, v32
    v_and_b32 v69, 0xffff0000, v32
    v_cvt_pk_bf16_f32 v33, v70, v71
    v_lshlrev_b32 v70, 16, v33
    v_and_b32 v71, 0xffff0000, v33
    v_pk_add_f32 v[68:69], v[68:69], v[244:245]
    v_pk_add_f32 v[70:71], v[70:71], v[246:247]
    v_cvt_pk_bf16_f32 v32, v68, v69
    v_lshlrev_b32 v68, 16, v32
    v_and_b32 v69, 0xffff0000, v32
    v_cvt_pk_bf16_f32 v33, v70, v71
    v_lshlrev_b32 v70, 16, v33
    v_and_b32 v71, 0xffff0000, v33
    v_pk_add_f32 v[68:69], v[68:69], v[104:105]
    v_pk_add_f32 v[70:71], v[70:71], v[106:107]
    v_cvt_pk_bf16_f32 v80, v68, v69
    v_cvt_pk_bf16_f32 v81, v70, v71
    buffer_store_dwordx2 v[80:81], v14, s[76:79], 0 offen offset:128
k1_end:
    s_endpgm
.section .rodata,"a"
.p2align 6
.amdhsa_kernel k1_kernel
  .amdhsa_next_free_vgpr 496
  .amdhsa_next_free_sgpr 102
  .amdhsa_accum_offset 256
  .amdhsa_group_segment_fixed_size 0
  .amdhsa_kernarg_size 80
  .amdhsa_user_sgpr_count 2
  .amdhsa_user_sgpr_kernarg_segment_ptr 1
  .amdhsa_system_sgpr_workgroup_id_x 1
.end_amdhsa_kernel
```
